```python
import torch

def _softmax(x, axis=-1):
    return torch.softmax(x, dim=axis)
def _gelu(x):
    return torch.nn.functional.gelu(x, approximate="tanh")
def _silu(x):
    return torch.nn.functional.silu(x)
def _sigmoid(x):
    return torch.sigmoid(x)
def _layernorm(x, axis=-1, eps=1e-5):
    m = x.mean(dim=axis, keepdim=True)
    v = x.var(dim=axis, keepdim=True, unbiased=False)
    return (x - m) / torch.sqrt(v + eps)
def _scatter_add(tgt, idx, src, axis=0):
    return tgt.clone().index_add_(axis, idx, src)
def _segment_sum(src, seg, n):
    out = torch.zeros((n,) + src.shape[1:], dtype=src.dtype)
    return out.index_add_(0, seg, src)
def _pad(x, pw):
    flat = tuple(v for pair in reversed(pw) for v in pair)
    return torch.nn.functional.pad(x, flat)

kernel_name = 'interleave_layers__grouped_kv_mqa__dense_activation_relu__prompt'

def setup_inputs():

    _w = (lambda a: (lambda t: t.to(torch.bfloat16) if t.is_floating_point() else t)(torch.as_tensor(a)))
    def _A_setup():
        B, S, D, H = 1, 2048, 512, 32
        Dh = D // H
        return {
            "x": _w((lambda *s: torch.randn(*s, dtype=torch.bfloat16) * 0.05)(B, S, D)),
            "wq": _w((lambda *s: torch.randn(*s, dtype=torch.bfloat16) * 0.05)(D, H * Dh)),
            "wk": _w((lambda *s: torch.randn(*s, dtype=torch.bfloat16) * 0.05)(D, Dh)),
            "wv": _w((lambda *s: torch.randn(*s, dtype=torch.bfloat16) * 0.05)(D, Dh)),
            "wo": _w((lambda *s: torch.randn(*s, dtype=torch.bfloat16) * 0.05)(H * Dh, D)),
        }
    _A_in = _A_setup()

    def _B_setup():
        B, S, D, Dff = 1, 2048, 512, 1792
        return {
            "x": _w((lambda *s: torch.randn(*s, dtype=torch.bfloat16) * 0.05)(B, S, D)),
            "w1": _w((lambda *s: torch.randn(*s, dtype=torch.bfloat16) * 0.05)(D, Dff)),
            "w2": _w((lambda *s: torch.randn(*s, dtype=torch.bfloat16) * 0.05)(Dff, D)),
        }
    _B_in = _B_setup()

    return {
        "A_x": _A_in["x"],
        "A_wq": _A_in["wq"],
        "A_wk": _A_in["wk"],
        "A_wv": _A_in["wv"],
        "A_wo": _A_in["wo"],
        "B_x": _B_in["x"],
        "B_w1": _B_in["w1"],
        "B_w2": _B_in["w2"],
    }

def reference(A_x, A_wq, A_wk, A_wv, A_wo, B_x, B_w1, B_w2):
    def _A_ref(x, wq, wk, wv, wo):
        B, S, D = x.shape
        H = 32
        Dh = D // H
        q = (lambda x, *d: x.permute(*d))((x @ wq).reshape(B, S, H, Dh), 0, 2, 1, 3)
        k = x @ wk
        v = x @ wv
        scores = torch.einsum("bhqd,bkd->bhqk", q, k) * (Dh ** -0.5)
        p = _softmax(scores, axis=-1)
        o = torch.einsum("bhqk,bkd->bhqd", p, v)
        return (lambda x, *d: x.permute(*d))(o, 0, 2, 1, 3).reshape(B, S, H * Dh) @ wo

    def _B_ref(x, w1, w2):
        h = torch.einsum("bsd,df->bsf", x, w1)
        zero = torch.zeros_like(h)
        h = torch.maximum(h, zero)
        return torch.einsum("bsf,fd->bsd", h, w2)

    x = A_x
    x = x + _A_ref(_layernorm(x, axis=-1), A_wq, A_wk, A_wv, A_wo)
    x = x + _B_ref(_layernorm(x, axis=-1), B_w1, B_w2)
    x = x + _A_ref(_layernorm(x, axis=-1), A_wq, A_wk, A_wv, A_wo)
    x = x + _B_ref(_layernorm(x, axis=-1), B_w1, B_w2)
    return x
```

```asm
; @launch kernel=pre_kernel grid=(256,1,1) block=(512,1,1) lds=160768
; @launch kernel=layer0_kernel grid=(256,1,1) block=(512,1,1) lds=160768
; @launch kernel=layer1_kernel grid=(256,1,1) block=(512,1,1) lds=160768
.amdgcn_target "amdgcn-amd-amdhsa--gfx950"
.text
.globl pre_kernel
.type pre_kernel,@function
    .p2align 8
pre_kernel:
    s_cmp_ge_u32 s2, 256
    s_cbranch_scc1 pre_kernel_exit
    s_load_dwordx16 s[16:31], s[0:1], 0
    s_load_dwordx4 s[32:35], s[0:1], 64
    s_load_dwordx2 s[36:37], s[0:1], 80
    v_lshrrev_b32 v2, 6, v0
    v_and_b32 v1, 63, v0
    v_readfirstlane_b32 s3, v2
    v_lshlrev_b32 v3, 4, v1
    s_waitcnt lgkmcnt(0)
    s_mov_b32 s40, s36
    s_and_b32 s41, s37, 0xffff
    s_mov_b32 s42, 38654976
    s_mov_b32 s43, 0x00020000
    s_and_b32 s60, s2, 7
    s_lshr_b32 s61, s2, 3
    s_lshl_b32 s5, s60, 2
    s_lshr_b32 s62, s61, 3
    s_add_u32 s5, s5, s62
    s_and_b32 s6, s61, 7
    s_mov_b32 s50, 0x3f803f80
    s_lshl_b32 s60, s6, 16
    s_lshl_b32 s61, s3, 12
    s_add_u32 s60, s60, s61
    s_add_u32 s44, s60, 34439168
    s_add_u32 s47, s60, 33882112
    s_min_u32 s51, s3, 6
    s_mul_i32 s60, s6, 7
    s_add_u32 s51, s51, s60
    s_lshl_b32 s45, s51, 15
    s_add_u32 s45, s45, 34963456
    s_mul_i32 s60, s6, 229376
    s_mul_i32 s61, s3, 14336
    s_add_u32 s46, s60, s61
    s_add_u32 s46, s46, 36798464
    s_mov_b32 s64, s16
    s_and_b32 s65, s17, 0xffff
    s_mov_b32 s66, 2097152
    s_mov_b32 s67, 0x00020000
    s_mov_b32 s72, s18
    s_and_b32 s73, s19, 0xffff
    s_mov_b32 s74, 524288
    s_mov_b32 s75, 0x00020000
    v_lshrrev_b32 v4, 3, v1
    v_and_b32 v5, 7, v1
    s_mov_b32 s55, 255
    s_mov_b32 s59, 0
    s_mov_b32 s4, 0
    v_mov_b32 v207, 0
    s_mov_b32 s62, 0
    s_mov_b32 s63, 0
    s_mov_b32 s68, s18
    s_and_b32 s69, s19, 0xffff
    s_mov_b32 s70, 524288
    s_mov_b32 s71, 0x00020000
    s_cmp_lt_u32 s6, 4
    s_cbranch_scc1 Lpre_np_1
    s_lshl_b32 s7, s5, 2
    s_add_u32 s7, s7, s6
    s_sub_u32 s7, s7, 4
    s_mov_b32 s49, 32
    s_cmp_ge_u32 s7, 126
    s_cbranch_scc1 Lpre_rs_7
    s_cmp_ge_u32 s7, 72
    s_cbranch_scc1 Lpre_rh_6
    s_and_b32 s60, s7, 1
    s_lshl_b32 s14, s60, 2
    s_add_u32 s14, s14, s3
    s_lshl_b32 s14, s14, 6
    s_cmp_ge_u32 s7, 16
    s_cbranch_scc1 Lpre_r1_3
    s_lshl_b32 s59, s60, 11
    s_add_u32 s59, s59, 38633472
    s_lshr_b32 s4, s7, 1
    s_lshl_b32 s4, s4, 6
    s_mov_b32 s60, s7
    s_cmp_eq_u32 s3, 4
    s_cbranch_scc1 Lpre_re_2
    s_cmp_gt_u32 s3, 4
    s_cbranch_scc1 Lpre_np_1
    s_mov_b32 s13, 1024
    s_mov_b32 s15, s4
    s_mov_b32 s48, 33882112
    s_mov_b32 s55, 1
    s_branch Lpre_rl_5
Lpre_r1_3:
    s_lshl_b32 s59, s60, 13
    s_add_u32 s59, s59, 38638592
    s_sub_u32 s4, s7, 16
    s_lshr_b32 s4, s4, 1
    s_lshl_b32 s4, s4, 6
    s_mov_b32 s60, s7
    s_cmp_eq_u32 s3, 4
    s_cbranch_scc1 Lpre_re_2
    s_cmp_gt_u32 s3, 4
    s_cbranch_scc1 Lpre_np_1
    s_mov_b32 s68, s28
    s_and_b32 s69, s29, 0xffff
    s_mov_b32 s70, 1835008
    s_mov_b32 s71, 0x00020000
    s_mov_b32 s13, 3584
    s_mov_b32 s15, s4
    s_mov_b32 s48, 34963456
    s_mov_b32 s55, 1
    s_branch Lpre_rl_5
Lpre_rs_7:
    s_sub_u32 s55, s7, 54
    s_branch Lpre_np_1
Lpre_rh_6:
    s_cmp_ge_u32 s3, 4
    s_cbranch_scc1 Lpre_np_1
    s_sub_u32 s60, s7, 72
    s_lshl_b32 s60, s60, 2
    s_add_u32 s60, s60, s3
    s_add_u32 s60, s60, 72
Lpre_re_2:
    s_mov_b32 s55, 0
    s_mov_b32 s13, 1024
    s_cmp_ge_u32 s60, 64
    s_cbranch_scc1 Lpre_r2_4
    s_mov_b32 s68, s24
    s_and_b32 s69, s25, 0xffff
    s_mov_b32 s70, 524288
    s_mov_b32 s71, 0x00020000
    s_lshr_b32 s15, s60, 3
    s_lshl_b32 s15, s15, 6
    s_and_b32 s14, s60, 7
    s_lshl_b32 s14, s14, 6
    s_mov_b32 s48, 34439168
    s_branch Lpre_rl_5
Lpre_r2_4:
    s_mov_b32 s68, s30
    s_and_b32 s69, s31, 0xffff
    s_mov_b32 s70, 1835008
    s_mov_b32 s71, 0x00020000
    s_sub_u32 s60, s60, 64
    s_mov_b32 s61, 153391690
    s_mul_hi_u32 s15, s60, s61
    s_mul_i32 s61, s15, 28
    s_sub_u32 s14, s60, s61
    s_lshl_b32 s14, s14, 6
    s_lshl_b32 s15, s15, 6
    s_mov_b32 s48, 36798464
    s_mov_b32 s49, 112
Lpre_rl_5:
    v_mul_u32_u24 v6, s13, v4
    v_lshl_add_u32 v6, v5, 4, v6
    s_mul_i32 s60, s14, s13
    s_lshl_b32 s61, s15, 1
    s_add_u32 s60, s60, s61
    s_lshl_b32 s63, s13, 3
    s_mov_b32 s62, s60
    v_mov_b32 v207, v6
Lpre_np_1:
    v_xor_b32 v6, v5, v4
    v_lshlrev_b32 v6, 4, v6
    v_lshl_add_u32 v6, v4, 10, v6
    v_lshlrev_b32 v7, 4, v5
    v_lshl_add_u32 v7, v4, 10, v7
    s_lshl_b32 s8, s5, 16
    s_lshl_b32 s9, s3, 7
    s_add_u32 s8, s8, s9
    s_lshl_b32 s10, s3, 13
    s_lshl_b32 s11, s3, 16
    s_lshl_b32 s9, s6, 7
    s_add_u32 s11, s11, s9
    s_and_b32 s61, s5, 3
    s_lshl_b32 s61, s61, 1
    s_add_u32 s60, s6, 0
    s_and_b32 s60, s60, 7
    s_lshl_b32 s12, s60, 10
    s_add_u32 m0, s10, s12
    s_lshl_b32 s12, s60, 13
    s_add_u32 s12, s12, s8
    buffer_load_dwordx4 v6, s[64:67], s12 offen lds
    s_add_u32 s60, s61, 0
    s_and_b32 s60, s60, 7
    s_lshl_b32 s12, s60, 10
    s_add_u32 s12, s12, 65536
    s_add_u32 m0, s10, s12
    s_lshl_b32 s12, s60, 13
    s_add_u32 s12, s12, s11
    buffer_load_dwordx4 v7, s[72:75], s12 offen lds
    s_add_u32 s60, s6, 1
    s_and_b32 s60, s60, 7
    s_lshl_b32 s12, s60, 10
    s_add_u32 m0, s10, s12
    s_lshl_b32 s12, s60, 13
    s_add_u32 s12, s12, s8
    buffer_load_dwordx4 v6, s[64:67], s12 offen lds
    s_add_u32 s60, s61, 1
    s_and_b32 s60, s60, 7
    s_lshl_b32 s12, s60, 10
    s_add_u32 s12, s12, 65536
    s_add_u32 m0, s10, s12
    s_lshl_b32 s12, s60, 13
    s_add_u32 s12, s12, s11
    buffer_load_dwordx4 v7, s[72:75], s12 offen lds
    s_add_u32 s60, s6, 2
    s_and_b32 s60, s60, 7
    s_lshl_b32 s12, s60, 10
    s_add_u32 m0, s10, s12
    s_lshl_b32 s12, s60, 13
    s_add_u32 s12, s12, s8
    buffer_load_dwordx4 v6, s[64:67], s12 offen lds
    s_add_u32 s60, s61, 2
    s_and_b32 s60, s60, 7
    s_lshl_b32 s12, s60, 10
    s_add_u32 s12, s12, 65536
    s_add_u32 m0, s10, s12
    s_lshl_b32 s12, s60, 13
    s_add_u32 s12, s12, s11
    buffer_load_dwordx4 v7, s[72:75], s12 offen lds
    s_add_u32 s60, s6, 3
    s_and_b32 s60, s60, 7
    s_lshl_b32 s12, s60, 10
    s_add_u32 m0, s10, s12
    s_lshl_b32 s12, s60, 13
    s_add_u32 s12, s12, s8
    buffer_load_dwordx4 v6, s[64:67], s12 offen lds
    s_add_u32 s60, s61, 3
    s_and_b32 s60, s60, 7
    s_lshl_b32 s12, s60, 10
    s_add_u32 s12, s12, 65536
    s_add_u32 m0, s10, s12
    s_lshl_b32 s12, s60, 13
    s_add_u32 s12, s12, s11
    buffer_load_dwordx4 v7, s[72:75], s12 offen lds
    s_add_u32 s60, s6, 4
    s_and_b32 s60, s60, 7
    s_lshl_b32 s12, s60, 10
    s_add_u32 m0, s10, s12
    s_lshl_b32 s12, s60, 13
    s_add_u32 s12, s12, s8
    buffer_load_dwordx4 v6, s[64:67], s12 offen lds
    s_add_u32 s60, s61, 4
    s_and_b32 s60, s60, 7
    s_lshl_b32 s12, s60, 10
    s_add_u32 s12, s12, 65536
    s_add_u32 m0, s10, s12
    s_lshl_b32 s12, s60, 13
    s_add_u32 s12, s12, s11
    buffer_load_dwordx4 v7, s[72:75], s12 offen lds
    s_add_u32 s60, s6, 5
    s_and_b32 s60, s60, 7
    s_lshl_b32 s12, s60, 10
    s_add_u32 m0, s10, s12
    s_lshl_b32 s12, s60, 13
    s_add_u32 s12, s12, s8
    buffer_load_dwordx4 v6, s[64:67], s12 offen lds
    s_add_u32 s60, s61, 5
    s_and_b32 s60, s60, 7
    s_lshl_b32 s12, s60, 10
    s_add_u32 s12, s12, 65536
    s_add_u32 m0, s10, s12
    s_lshl_b32 s12, s60, 13
    s_add_u32 s12, s12, s11
    buffer_load_dwordx4 v7, s[72:75], s12 offen lds
    s_add_u32 s60, s6, 6
    s_and_b32 s60, s60, 7
    s_lshl_b32 s12, s60, 10
    s_add_u32 m0, s10, s12
    s_lshl_b32 s12, s60, 13
    s_add_u32 s12, s12, s8
    buffer_load_dwordx4 v6, s[64:67], s12 offen lds
    s_add_u32 s60, s61, 6
    s_and_b32 s60, s60, 7
    s_lshl_b32 s12, s60, 10
    s_add_u32 s12, s12, 65536
    s_add_u32 m0, s10, s12
    s_lshl_b32 s12, s60, 13
    s_add_u32 s12, s12, s11
    buffer_load_dwordx4 v7, s[72:75], s12 offen lds
    s_add_u32 s60, s6, 7
    s_and_b32 s60, s60, 7
    s_lshl_b32 s12, s60, 10
    s_add_u32 m0, s10, s12
    s_lshl_b32 s12, s60, 13
    s_add_u32 s12, s12, s8
    buffer_load_dwordx4 v6, s[64:67], s12 offen lds
    s_add_u32 s60, s61, 7
    s_and_b32 s60, s60, 7
    s_lshl_b32 s12, s60, 10
    s_add_u32 s12, s12, 65536
    s_add_u32 m0, s10, s12
    s_lshl_b32 s12, s60, 13
    s_add_u32 s12, s12, s11
    buffer_load_dwordx4 v7, s[72:75], s12 offen lds
    v_lshrrev_b32 v5, 5, v1
    v_lshrrev_b32 v8, 4, v1
    v_and_b32 v9, 1, v8
    v_and_b32 v10, 15, v1
    v_lshrrev_b32 v11, 2, v10
    v_and_b32 v10, 3, v10
    s_lshl_b32 s12, s3, 11
    s_add_u32 s12, s12, 143360
    v_mov_b32 v14, 0
    v_mov_b32 v15, 0
    s_cmp_ge_u32 s6, 4
    s_cbranch_scc1 Lpre_m4_10
    s_cmp_ge_u32 s6, 2
    s_cbranch_scc1 Lpre_wv_12
    s_mov_b32 s68, s20
    s_and_b32 s69, s21, 0xffff
    s_mov_b32 s70, 16384
    s_mov_b32 s71, 0x00020000
    s_branch Lpre_kvd_13
Lpre_wv_12:
    s_mov_b32 s68, s22
    s_and_b32 s69, s23, 0xffff
    s_mov_b32 s70, 16384
    s_mov_b32 s71, 0x00020000
Lpre_kvd_13:
    s_lshl_b32 s9, s3, 11
    s_mov_b32 m0, s12
    s_nop 0
    buffer_load_dwordx4 v3, s[68:71], s9 offen lds
    buffer_load_dwordx4 v3, s[68:71], s9 offen offset:1024 lds
Lpre_z2_14:
    s_waitcnt vmcnt(0)
    s_branch Lpre_go_11
Lpre_m4_10:
    s_cmp_ge_u32 s55, 72
    s_cbranch_scc1 Lpre_z2_14
    buffer_load_dwordx4 v[80:83], v207, s[68:71], s62 offen
    s_add_u32 s62, s62, s63
    buffer_load_dwordx4 v[84:87], v207, s[68:71], s62 offen
    s_add_u32 s62, s62, s63
    buffer_load_dwordx4 v[88:91], v207, s[68:71], s62 offen
    s_add_u32 s62, s62, s63
    buffer_load_dwordx4 v[92:95], v207, s[68:71], s62 offen
    s_add_u32 s62, s62, s63
    buffer_load_dwordx4 v[128:131], v207, s[68:71], s62 offen
    s_add_u32 s62, s62, s63
    buffer_load_dwordx4 v[132:135], v207, s[68:71], s62 offen
    s_add_u32 s62, s62, s63
    buffer_load_dwordx4 v[136:139], v207, s[68:71], s62 offen
    s_add_u32 s62, s62, s63
    buffer_load_dwordx4 v[140:143], v207, s[68:71], s62 offen
    s_add_u32 s62, s62, s63
    s_waitcnt vmcnt(8)
Lpre_go_11:
    s_mov_b32 s63, s12
    v_and_b32 v4, 31, v1
    v_and_b32 v6, 7, v1
    v_lshlrev_b32 v7, 7, v4
    v_add_u32 v7, s10, v7
    v_add_u32 v8, 0, v5
    v_xor_b32 v8, v8, v6
    v_lshl_add_u32 v8, v8, 4, v7
    ds_read_b128 v[208:211], v8 offset:0
    ds_read_b128 v[212:215], v8 offset:4096
    v_add_u32 v8, 2, v5
    v_xor_b32 v8, v8, v6
    v_lshl_add_u32 v8, v8, 4, v7
    ds_read_b128 v[216:219], v8 offset:0
    ds_read_b128 v[220:223], v8 offset:4096
    v_add_u32 v8, 4, v5
    v_xor_b32 v8, v8, v6
    v_lshl_add_u32 v8, v8, 4, v7
    ds_read_b128 v[224:227], v8 offset:0
    ds_read_b128 v[228:231], v8 offset:4096
    v_add_u32 v8, 6, v5
    v_xor_b32 v8, v8, v6
    v_lshl_add_u32 v8, v8, 4, v7
    ds_read_b128 v[232:235], v8 offset:0
    ds_read_b128 v[236:239], v8 offset:4096
    v_lshl_add_u32 v12, v5, 3, v11
    v_lshlrev_b32 v13, 7, v12
    v_lshl_add_u32 v13, v9, 5, v13
    v_lshl_add_u32 v13, v10, 3, v13
    v_add_u32 v13, s10, v13
    v_add_u32 v13, 65536, v13
    v_lshlrev_b32 v14, 5, v12
    v_lshl_add_u32 v14, v10, 3, v14
    v_add_u32 v14, s12, v14
    s_waitcnt lgkmcnt(0)
    ds_read_b64_tr_b16 v[96:97], v13 offset:0
    ds_read_b64_tr_b16 v[98:99], v13 offset:512
    ds_read_b64_tr_b16 v[100:101], v13 offset:2048
    ds_read_b64_tr_b16 v[102:103], v13 offset:2560
    ds_read_b64_tr_b16 v[104:105], v13 offset:4096
    ds_read_b64_tr_b16 v[106:107], v13 offset:4608
    ds_read_b64_tr_b16 v[108:109], v13 offset:6144
    ds_read_b64_tr_b16 v[110:111], v13 offset:6656
    s_waitcnt lgkmcnt(0)
    ds_read_b64_tr_b16 v[112:113], v13 offset:64
    ds_read_b64_tr_b16 v[114:115], v13 offset:576
    ds_read_b64_tr_b16 v[116:117], v13 offset:2112
    ds_read_b64_tr_b16 v[118:119], v13 offset:2624
    ds_read_b64_tr_b16 v[120:121], v13 offset:4160
    ds_read_b64_tr_b16 v[122:123], v13 offset:4672
    ds_read_b64_tr_b16 v[124:125], v13 offset:6208
    ds_read_b64_tr_b16 v[126:127], v13 offset:6720
    s_waitcnt lgkmcnt(0)
    s_cmp_ge_u32 s6, 4
    s_cbranch_scc1 Lpre_nokv_15
    ds_read_b64_tr_b16 v[128:129], v14 offset:0
    ds_read_b64_tr_b16 v[130:131], v14 offset:128
    ds_read_b64_tr_b16 v[132:133], v14 offset:512
    ds_read_b64_tr_b16 v[134:135], v14 offset:640
    ds_read_b64_tr_b16 v[136:137], v14 offset:1024
    ds_read_b64_tr_b16 v[138:139], v14 offset:1152
    ds_read_b64_tr_b16 v[140:141], v14 offset:1536
    ds_read_b64_tr_b16 v[142:143], v14 offset:1664
    s_waitcnt lgkmcnt(0)
Lpre_nokv_15:
    s_lshr_b32 s60, s3, 1
    s_and_b32 s56, s60, 1
    s_lshl_b32 s61, s5, 1
    s_add_u32 s56, s56, s61
    s_lshr_b32 s57, s3, 2
    s_lshl_b32 s61, s6, 1
    s_add_u32 s57, s57, s61
    s_lshl_b32 s57, s57, 1
    s_and_b32 s61, s3, 1
    s_add_u32 s57, s57, s61
    s_lshl_b32 s58, s56, 5
    s_add_u32 s58, s58, s57
    s_lshl_b32 s58, s58, 10
    s_add_u32 s58, s58, 4358144
    v_mov_b32 v8, 0
    v_mov_b32 v192, s50
    v_mov_b32 v9, 0
    v_mov_b32 v193, s50
    v_mov_b32 v10, 0
    v_mov_b32 v194, s50
    v_mov_b32 v11, 0
    v_mov_b32 v195, s50
    v_mfma_f32_32x32x16_bf16 v[16:31], v[96:99], v[208:211], 0
    v_mfma_f32_32x32x16_bf16 v[32:47], v[96:99], v[212:215], 0
    v_mfma_f32_32x32x16_bf16 v[144:159], v[192:195], v[96:99], 0
    v_mfma_f32_32x32x16_bf16 v[48:63], v[112:115], v[208:211], 0
    v_mfma_f32_32x32x16_bf16 v[64:79], v[112:115], v[212:215], 0
    v_mfma_f32_32x32x16_bf16 v[160:175], v[192:195], v[112:115], 0
    v_dot2_f32_bf16 v8, v208, s50, v8
    v_dot2_f32_bf16 v9, v208, v208, v9
    v_dot2_f32_bf16 v8, v209, s50, v8
    v_dot2_f32_bf16 v9, v209, v209, v9
    v_dot2_f32_bf16 v8, v210, s50, v8
    v_dot2_f32_bf16 v9, v210, v210, v9
    v_dot2_f32_bf16 v8, v211, s50, v8
    v_dot2_f32_bf16 v9, v211, v211, v9
    v_dot2_f32_bf16 v10, v212, s50, v10
    v_dot2_f32_bf16 v11, v212, v212, v11
    v_dot2_f32_bf16 v10, v213, s50, v10
    v_dot2_f32_bf16 v11, v213, v213, v11
    v_dot2_f32_bf16 v10, v214, s50, v10
    v_dot2_f32_bf16 v11, v214, v214, v11
    v_dot2_f32_bf16 v10, v215, s50, v10
    v_dot2_f32_bf16 v11, v215, v215, v11
    v_mfma_f32_32x32x16_bf16 v[16:31], v[100:103], v[216:219], v[16:31]
    v_mfma_f32_32x32x16_bf16 v[32:47], v[100:103], v[220:223], v[32:47]
    v_mfma_f32_32x32x16_bf16 v[144:159], v[192:195], v[100:103], v[144:159]
    v_mfma_f32_32x32x16_bf16 v[48:63], v[116:119], v[216:219], v[48:63]
    v_mfma_f32_32x32x16_bf16 v[64:79], v[116:119], v[220:223], v[64:79]
    v_mfma_f32_32x32x16_bf16 v[160:175], v[192:195], v[116:119], v[160:175]
    v_dot2_f32_bf16 v8, v216, s50, v8
    v_dot2_f32_bf16 v9, v216, v216, v9
    v_dot2_f32_bf16 v8, v217, s50, v8
    v_dot2_f32_bf16 v9, v217, v217, v9
    v_dot2_f32_bf16 v8, v218, s50, v8
    v_dot2_f32_bf16 v9, v218, v218, v9
    v_dot2_f32_bf16 v8, v219, s50, v8
    v_dot2_f32_bf16 v9, v219, v219, v9
    v_dot2_f32_bf16 v10, v220, s50, v10
    v_dot2_f32_bf16 v11, v220, v220, v11
    v_dot2_f32_bf16 v10, v221, s50, v10
    v_dot2_f32_bf16 v11, v221, v221, v11
    v_dot2_f32_bf16 v10, v222, s50, v10
    v_dot2_f32_bf16 v11, v222, v222, v11
    v_dot2_f32_bf16 v10, v223, s50, v10
    v_dot2_f32_bf16 v11, v223, v223, v11
    v_mfma_f32_32x32x16_bf16 v[16:31], v[104:107], v[224:227], v[16:31]
    v_mfma_f32_32x32x16_bf16 v[32:47], v[104:107], v[228:231], v[32:47]
    v_mfma_f32_32x32x16_bf16 v[144:159], v[192:195], v[104:107], v[144:159]
    v_mfma_f32_32x32x16_bf16 v[48:63], v[120:123], v[224:227], v[48:63]
    v_mfma_f32_32x32x16_bf16 v[64:79], v[120:123], v[228:231], v[64:79]
    v_mfma_f32_32x32x16_bf16 v[160:175], v[192:195], v[120:123], v[160:175]
    v_dot2_f32_bf16 v8, v224, s50, v8
    v_dot2_f32_bf16 v9, v224, v224, v9
    v_dot2_f32_bf16 v8, v225, s50, v8
    v_dot2_f32_bf16 v9, v225, v225, v9
    v_dot2_f32_bf16 v8, v226, s50, v8
    v_dot2_f32_bf16 v9, v226, v226, v9
    v_dot2_f32_bf16 v8, v227, s50, v8
    v_dot2_f32_bf16 v9, v227, v227, v9
    v_dot2_f32_bf16 v10, v228, s50, v10
    v_dot2_f32_bf16 v11, v228, v228, v11
    v_dot2_f32_bf16 v10, v229, s50, v10
    v_dot2_f32_bf16 v11, v229, v229, v11
    v_dot2_f32_bf16 v10, v230, s50, v10
    v_dot2_f32_bf16 v11, v230, v230, v11
    v_dot2_f32_bf16 v10, v231, s50, v10
    v_dot2_f32_bf16 v11, v231, v231, v11
    v_mfma_f32_32x32x16_bf16 v[16:31], v[108:111], v[232:235], v[16:31]
    v_mfma_f32_32x32x16_bf16 v[32:47], v[108:111], v[236:239], v[32:47]
    v_mfma_f32_32x32x16_bf16 v[144:159], v[192:195], v[108:111], v[144:159]
    v_mfma_f32_32x32x16_bf16 v[48:63], v[124:127], v[232:235], v[48:63]
    v_mfma_f32_32x32x16_bf16 v[64:79], v[124:127], v[236:239], v[64:79]
    v_mfma_f32_32x32x16_bf16 v[160:175], v[192:195], v[124:127], v[160:175]
    v_dot2_f32_bf16 v8, v232, s50, v8
    v_dot2_f32_bf16 v9, v232, v232, v9
    v_dot2_f32_bf16 v8, v233, s50, v8
    v_dot2_f32_bf16 v9, v233, v233, v9
    v_dot2_f32_bf16 v8, v234, s50, v8
    v_dot2_f32_bf16 v9, v234, v234, v9
    v_dot2_f32_bf16 v8, v235, s50, v8
    v_dot2_f32_bf16 v9, v235, v235, v9
    v_dot2_f32_bf16 v10, v236, s50, v10
    v_dot2_f32_bf16 v11, v236, v236, v11
    v_dot2_f32_bf16 v10, v237, s50, v10
    v_dot2_f32_bf16 v11, v237, v237, v11
    v_dot2_f32_bf16 v10, v238, s50, v10
    v_dot2_f32_bf16 v11, v238, v238, v11
    v_dot2_f32_bf16 v10, v239, s50, v10
    v_dot2_f32_bf16 v11, v239, v239, v11
    s_cmp_ge_u32 s6, 4
    s_cbranch_scc1 Lpre_kve_16
    v_mfma_f32_32x32x16_bf16 v[176:191], v[192:195], v[128:131], 0
    v_mfma_f32_32x32x16_bf16 v[176:191], v[192:195], v[132:135], v[176:191]
    v_mfma_f32_32x32x16_bf16 v[176:191], v[192:195], v[136:139], v[176:191]
    v_mfma_f32_32x32x16_bf16 v[176:191], v[192:195], v[140:143], v[176:191]
    s_cmp_lg_u32 s6, 0
    s_cbranch_scc1 Lpre_kvn_17
    v_mfma_f32_32x32x16_bf16 v[80:95], v[128:131], v[208:211], 0
    v_mfma_f32_32x32x16_bf16 v[80:95], v[132:135], v[216:219], v[80:95]
    v_mfma_f32_32x32x16_bf16 v[80:95], v[136:139], v[224:227], v[80:95]
    v_mfma_f32_32x32x16_bf16 v[80:95], v[140:143], v[232:235], v[80:95]
    s_branch Lpre_kve_16
Lpre_kvn_17:
    s_cmp_lg_u32 s6, 1
    s_cbranch_scc1 Lpre_kvn_18
    v_mfma_f32_32x32x16_bf16 v[80:95], v[128:131], v[212:215], 0
    v_mfma_f32_32x32x16_bf16 v[80:95], v[132:135], v[220:223], v[80:95]
    v_mfma_f32_32x32x16_bf16 v[80:95], v[136:139], v[228:231], v[80:95]
    v_mfma_f32_32x32x16_bf16 v[80:95], v[140:143], v[236:239], v[80:95]
    s_branch Lpre_kve_16
Lpre_kvn_18:
    s_cmp_lg_u32 s6, 2
    s_cbranch_scc1 Lpre_kvn_19
    v_mfma_f32_32x32x16_bf16 v[80:95], v[208:211], v[128:131], 0
    v_mfma_f32_32x32x16_bf16 v[80:95], v[216:219], v[132:135], v[80:95]
    v_mfma_f32_32x32x16_bf16 v[80:95], v[224:227], v[136:139], v[80:95]
    v_mfma_f32_32x32x16_bf16 v[80:95], v[232:235], v[140:143], v[80:95]
    s_branch Lpre_kve_16
Lpre_kvn_19:
    s_cmp_lg_u32 s6, 3
    s_cbranch_scc1 Lpre_kvn_20
    v_mfma_f32_32x32x16_bf16 v[80:95], v[212:215], v[128:131], 0
    v_mfma_f32_32x32x16_bf16 v[80:95], v[220:223], v[132:135], v[80:95]
    v_mfma_f32_32x32x16_bf16 v[80:95], v[228:231], v[136:139], v[80:95]
    v_mfma_f32_32x32x16_bf16 v[80:95], v[236:239], v[140:143], v[80:95]
    s_branch Lpre_kve_16
Lpre_kvn_20:
Lpre_kve_16:
    s_nop 3
    v_mov_b32 v4, v8
    v_mov_b32 v5, v9
    v_mov_b32 v6, v10
    v_mov_b32 v7, v11
    s_lshl_b32 s60, s3, 9
    v_and_b32 v14, 31, v1
    v_permlane32_swap_b32 v8, v4
    v_permlane32_swap_b32 v9, v5
    v_permlane32_swap_b32 v10, v6
    v_permlane32_swap_b32 v11, v7
    v_lshlrev_b32 v14, 4, v14
    v_add_u32 v14, 135168, v14
    v_add_f32 v8, v8, v4
    v_add_f32 v9, v9, v5
    v_add_f32 v10, v10, v6
    v_add_f32 v11, v11, v7
    v_add_u32 v4, s60, v14
    s_nop 5
    v_mov_b32 v204, 0
    v_mov_b32 v205, 0
    s_cmp_ge_u32 s55, 74
    s_cbranch_scc1 Lpre_pc0_25
    v_lshrrev_b32 v196, 5, v1
    v_lshrrev_b32 v197, 4, v1
    v_and_b32 v197, 1, v197
    v_and_b32 v198, 15, v1
    v_lshrrev_b32 v199, 2, v198
    v_and_b32 v198, 3, v198
    v_lshl_add_u32 v200, v196, 2, v199
    v_add_u32 v202, s63, v3
    s_cmp_eq_u32 s55, 73
    s_cbranch_scc1 Lpre_pz_22
    s_cmp_eq_u32 s55, 72
    s_cbranch_scc1 Lpre_pkv_23
    v_lshlrev_b32 v201, 7, v200
    v_lshl_add_u32 v201, v197, 5, v201
    v_lshl_add_u32 v201, v198, 3, v201
    v_add_u32 v201, s63, v201
    s_lshr_b32 s60, s15, 5
    s_mul_i32 s60, s60, s49
    s_lshr_b32 s61, s14, 4
    s_add_u32 s60, s60, s61
    s_lshl_b32 s60, s60, 10
    s_add_u32 s60, s60, s48
    s_lshl_b32 s61, s49, 10
    s_add_u32 s61, s61, s60
    s_waitcnt vmcnt(0)
    ds_write_b128 v202, v[80:83]
    ds_write_b128 v202, v[84:87] offset:1024
    ds_read_b64_tr_b16 v[208:209], v201 offset:0
    ds_read_b64_tr_b16 v[210:211], v201 offset:1024
    ds_read_b64_tr_b16 v[224:225], v201 offset:64
    ds_read_b64_tr_b16 v[226:227], v201 offset:1088
    s_waitcnt lgkmcnt(0)
    buffer_store_dwordx4 v[208:211], v3, s[40:43], s60 offen offset:0 sc1
    buffer_store_dwordx4 v[224:227], v3, s[40:43], s61 offen offset:0 sc1
    ds_write_b128 v202, v[88:91]
    ds_write_b128 v202, v[92:95] offset:1024
    ds_read_b64_tr_b16 v[212:213], v201 offset:0
    ds_read_b64_tr_b16 v[214:215], v201 offset:1024
    ds_read_b64_tr_b16 v[228:229], v201 offset:64
    ds_read_b64_tr_b16 v[230:231], v201 offset:1088
    s_waitcnt lgkmcnt(0)
    buffer_store_dwordx4 v[212:215], v3, s[40:43], s60 offen offset:1024 sc1
    buffer_store_dwordx4 v[228:231], v3, s[40:43], s61 offen offset:1024 sc1
    ds_write_b128 v202, v[128:131]
    ds_write_b128 v202, v[132:135] offset:1024
    ds_read_b64_tr_b16 v[216:217], v201 offset:0
    ds_read_b64_tr_b16 v[218:219], v201 offset:1024
    ds_read_b64_tr_b16 v[232:233], v201 offset:64
    ds_read_b64_tr_b16 v[234:235], v201 offset:1088
    s_waitcnt lgkmcnt(0)
    buffer_store_dwordx4 v[216:219], v3, s[40:43], s60 offen offset:2048 sc1
    buffer_store_dwordx4 v[232:235], v3, s[40:43], s61 offen offset:2048 sc1
    ds_write_b128 v202, v[136:139]
    ds_write_b128 v202, v[140:143] offset:1024
    ds_read_b64_tr_b16 v[220:221], v201 offset:0
    ds_read_b64_tr_b16 v[222:223], v201 offset:1024
    ds_read_b64_tr_b16 v[236:237], v201 offset:64
    ds_read_b64_tr_b16 v[238:239], v201 offset:1088
    s_waitcnt lgkmcnt(0)
    buffer_store_dwordx4 v[220:223], v3, s[40:43], s60 offen offset:3072 sc1
    buffer_store_dwordx4 v[236:239], v3, s[40:43], s61 offen offset:3072 sc1
    s_cmp_eq_u32 s55, 0
    s_cbranch_scc1 Lpre_pc0_25
    v_dot2_f32_bf16 v204, v208, s50, v204
    v_dot2_f32_bf16 v204, v209, s50, v204
    v_dot2_f32_bf16 v204, v210, s50, v204
    v_dot2_f32_bf16 v204, v211, s50, v204
    v_dot2_f32_bf16 v204, v212, s50, v204
    v_dot2_f32_bf16 v204, v213, s50, v204
    v_dot2_f32_bf16 v204, v214, s50, v204
    v_dot2_f32_bf16 v204, v215, s50, v204
    v_dot2_f32_bf16 v204, v216, s50, v204
    v_dot2_f32_bf16 v204, v217, s50, v204
    v_dot2_f32_bf16 v204, v218, s50, v204
    v_dot2_f32_bf16 v204, v219, s50, v204
    v_dot2_f32_bf16 v204, v220, s50, v204
    v_dot2_f32_bf16 v204, v221, s50, v204
    v_dot2_f32_bf16 v204, v222, s50, v204
    v_dot2_f32_bf16 v204, v223, s50, v204
    v_dot2_f32_bf16 v205, v224, s50, v205
    v_dot2_f32_bf16 v205, v225, s50, v205
    v_dot2_f32_bf16 v205, v226, s50, v205
    v_dot2_f32_bf16 v205, v227, s50, v205
    v_dot2_f32_bf16 v205, v228, s50, v205
    v_dot2_f32_bf16 v205, v229, s50, v205
    v_dot2_f32_bf16 v205, v230, s50, v205
    v_dot2_f32_bf16 v205, v231, s50, v205
    v_dot2_f32_bf16 v205, v232, s50, v205
    v_dot2_f32_bf16 v205, v233, s50, v205
    v_dot2_f32_bf16 v205, v234, s50, v205
    v_dot2_f32_bf16 v205, v235, s50, v205
    v_dot2_f32_bf16 v205, v236, s50, v205
    v_dot2_f32_bf16 v205, v237, s50, v205
    v_dot2_f32_bf16 v205, v238, s50, v205
    v_dot2_f32_bf16 v205, v239, s50, v205
Lpre_pc0_25:
    s_cmp_eq_u32 s59, 0
    s_cbranch_scc1 Lpre_pe_21
Lpre_pcs_24:
    s_nop 3
    v_mov_b32 v200, v204
    v_mov_b32 v201, v205
    v_and_b32 v196, 31, v1
    v_lshlrev_b32 v196, 2, v196
    v_permlane32_swap_b32 v204, v200
    v_permlane32_swap_b32 v205, v201
    v_add_u32 v196, s63, v196
    s_nop 0
    v_add_f32 v204, v204, v200
    v_add_f32 v205, v205, v201
    ds_write_b32 v196, v204
    ds_write_b32 v196, v205 offset:128
    s_branch Lpre_pe_21
Lpre_pkv_23:
    s_mov_b32 s68, s20
    s_and_b32 s69, s21, 0xffff
    s_mov_b32 s70, 16384
    s_mov_b32 s71, 0x00020000
    s_mov_b32 s76, s22
    s_and_b32 s77, s23, 0xffff
    s_mov_b32 s78, 16384
    s_mov_b32 s79, 0x00020000
    v_lshlrev_b32 v201, 5, v200
    v_lshl_add_u32 v201, v197, 10, v201
    v_lshl_add_u32 v201, v198, 3, v201
    v_add_u32 v201, s63, v201
    s_lshl_b32 s60, s3, 12
    s_add_u32 s60, s60, 34406400
    s_mov_b32 s59, 38637568
    s_mov_b32 s4, 0
    s_lshl_b32 s9, s3, 11
    buffer_load_dwordx4 v[80:83], v3, s[68:71], s9 offen
    buffer_load_dwordx4 v[84:87], v3, s[76:79], s9 offen
    buffer_load_dwordx4 v[88:91], v3, s[68:71], s9 offen offset:1024
    buffer_load_dwordx4 v[92:95], v3, s[76:79], s9 offen offset:1024
    s_waitcnt vmcnt(0)
    ds_write_b128 v202, v[80:83]
    ds_write_b128 v202, v[84:87] offset:1024
    ds_read_b64_tr_b16 v[208:209], v201 offset:0
    ds_read_b64_tr_b16 v[210:211], v201 offset:256
    ds_read_b64_tr_b16 v[212:213], v201 offset:512
    ds_read_b64_tr_b16 v[214:215], v201 offset:768
    s_waitcnt lgkmcnt(0)
    ds_write_b128 v202, v[88:91]
    ds_write_b128 v202, v[92:95] offset:1024
    ds_read_b64_tr_b16 v[216:217], v201 offset:0
    ds_read_b64_tr_b16 v[218:219], v201 offset:256
    ds_read_b64_tr_b16 v[220:221], v201 offset:512
    ds_read_b64_tr_b16 v[222:223], v201 offset:768
    s_waitcnt lgkmcnt(0)
    buffer_store_dwordx4 v[208:211], v3, s[40:43], s60 offen offset:0
    buffer_store_dwordx4 v[212:215], v3, s[40:43], s60 offen offset:1024
    buffer_store_dwordx4 v[216:219], v3, s[40:43], s60 offen offset:2048
    buffer_store_dwordx4 v[220:223], v3, s[40:43], s60 offen offset:3072
    v_dot2_f32_bf16 v204, v208, s50, v204
    v_dot2_f32_bf16 v204, v209, s50, v204
    v_dot2_f32_bf16 v204, v210, s50, v204
    v_dot2_f32_bf16 v204, v211, s50, v204
    v_dot2_f32_bf16 v204, v212, s50, v204
    v_dot2_f32_bf16 v204, v213, s50, v204
    v_dot2_f32_bf16 v204, v214, s50, v204
    v_dot2_f32_bf16 v204, v215, s50, v204
    v_dot2_f32_bf16 v204, v216, s50, v204
    v_dot2_f32_bf16 v204, v217, s50, v204
    v_dot2_f32_bf16 v204, v218, s50, v204
    v_dot2_f32_bf16 v204, v219, s50, v204
    v_dot2_f32_bf16 v204, v220, s50, v204
    v_dot2_f32_bf16 v204, v221, s50, v204
    v_dot2_f32_bf16 v204, v222, s50, v204
    v_dot2_f32_bf16 v204, v223, s50, v204
    s_branch Lpre_pcs_24
Lpre_pz_22:
    v_mov_b32 v206, 0
    v_mov_b32 v207, 0
    s_and_b32 s60, s3, 3
    s_mul_i32 s60, s60, 6144
    s_lshr_b32 s61, s3, 2
    s_mul_i32 s61, s61, 16941056
    s_add_u32 s60, s60, s61
    s_add_u32 s60, s60, 0
    s_add_u32 s61, s60, 4096
    buffer_store_dwordx4 v[204:207], v3, s[40:43], s60 offen offset:0
    buffer_store_dwordx4 v[204:207], v3, s[40:43], s60 offen offset:1024
    buffer_store_dwordx4 v[204:207], v3, s[40:43], s60 offen offset:2048
    buffer_store_dwordx4 v[204:207], v3, s[40:43], s60 offen offset:3072
    buffer_store_dwordx4 v[204:207], v3, s[40:43], s61 offen offset:0
    buffer_store_dwordx4 v[204:207], v3, s[40:43], s61 offen offset:1024
Lpre_pe_21:
    s_waitcnt lgkmcnt(0)
    s_barrier
    ds_write_b128 v4, v[8:11]
    s_mul_i32 s60, s3, 384
    v_and_b32 v5, 31, v1
    v_lshlrev_b32 v5, 2, v5
    v_add_u32 v5, s60, v5
    v_add_u32 v5, 139264, v5
    ds_write_b32 v5, v144
    ds_write_b32 v5, v160 offset:128
    ds_write_b32 v5, v176 offset:256
    s_lshl_b32 s60, s3, 14
    v_add_u32 v0, s60, v3
    s_cmp_eq_u32 s3, 0
    s_cbranch_scc1 Lpre_rw_26
    ds_write_b128 v0, v[16:19] offset:0
    ds_write_b128 v0, v[20:23] offset:1024
    s_branch Lpre_rx_27
Lpre_rw_26:
    v_mov_b32 v4, v16
    v_mov_b32 v5, v17
    v_mov_b32 v6, v18
    v_mov_b32 v7, v19
    v_mov_b32 v8, v20
    v_mov_b32 v9, v21
    v_mov_b32 v10, v22
    v_mov_b32 v11, v23
Lpre_rx_27:
    s_cmp_eq_u32 s3, 1
    s_cbranch_scc1 Lpre_rw_28
    ds_write_b128 v0, v[24:27] offset:2048
    ds_write_b128 v0, v[28:31] offset:3072
    s_branch Lpre_rx_29
Lpre_rw_28:
    v_mov_b32 v4, v24
    v_mov_b32 v5, v25
    v_mov_b32 v6, v26
    v_mov_b32 v7, v27
    v_mov_b32 v8, v28
    v_mov_b32 v9, v29
    v_mov_b32 v10, v30
    v_mov_b32 v11, v31
Lpre_rx_29:
    s_cmp_eq_u32 s3, 2
    s_cbranch_scc1 Lpre_rw_30
    ds_write_b128 v0, v[32:35] offset:4096
    ds_write_b128 v0, v[36:39] offset:5120
    s_branch Lpre_rx_31
Lpre_rw_30:
    v_mov_b32 v4, v32
    v_mov_b32 v5, v33
    v_mov_b32 v6, v34
    v_mov_b32 v7, v35
    v_mov_b32 v8, v36
    v_mov_b32 v9, v37
    v_mov_b32 v10, v38
    v_mov_b32 v11, v39
Lpre_rx_31:
    s_cmp_eq_u32 s3, 3
    s_cbranch_scc1 Lpre_rw_32
    ds_write_b128 v0, v[40:43] offset:6144
    ds_write_b128 v0, v[44:47] offset:7168
    s_branch Lpre_rx_33
Lpre_rw_32:
    v_mov_b32 v4, v40
    v_mov_b32 v5, v41
    v_mov_b32 v6, v42
    v_mov_b32 v7, v43
    v_mov_b32 v8, v44
    v_mov_b32 v9, v45
    v_mov_b32 v10, v46
    v_mov_b32 v11, v47
Lpre_rx_33:
    s_cmp_eq_u32 s3, 4
    s_cbranch_scc1 Lpre_rw_34
    ds_write_b128 v0, v[48:51] offset:8192
    ds_write_b128 v0, v[52:55] offset:9216
    s_branch Lpre_rx_35
Lpre_rw_34:
    v_mov_b32 v4, v48
    v_mov_b32 v5, v49
    v_mov_b32 v6, v50
    v_mov_b32 v7, v51
    v_mov_b32 v8, v52
    v_mov_b32 v9, v53
    v_mov_b32 v10, v54
    v_mov_b32 v11, v55
Lpre_rx_35:
    s_cmp_eq_u32 s3, 5
    s_cbranch_scc1 Lpre_rw_36
    ds_write_b128 v0, v[56:59] offset:10240
    ds_write_b128 v0, v[60:63] offset:11264
    s_branch Lpre_rx_37
Lpre_rw_36:
    v_mov_b32 v4, v56
    v_mov_b32 v5, v57
    v_mov_b32 v6, v58
    v_mov_b32 v7, v59
    v_mov_b32 v8, v60
    v_mov_b32 v9, v61
    v_mov_b32 v10, v62
    v_mov_b32 v11, v63
Lpre_rx_37:
    s_cmp_eq_u32 s3, 6
    s_cbranch_scc1 Lpre_rw_38
    ds_write_b128 v0, v[64:67] offset:12288
    ds_write_b128 v0, v[68:71] offset:13312
    s_branch Lpre_rx_39
Lpre_rw_38:
    v_mov_b32 v4, v64
    v_mov_b32 v5, v65
    v_mov_b32 v6, v66
    v_mov_b32 v7, v67
    v_mov_b32 v8, v68
    v_mov_b32 v9, v69
    v_mov_b32 v10, v70
    v_mov_b32 v11, v71
Lpre_rx_39:
    s_cmp_eq_u32 s3, 7
    s_cbranch_scc1 Lpre_rw_40
    ds_write_b128 v0, v[72:75] offset:14336
    ds_write_b128 v0, v[76:79] offset:15360
    s_branch Lpre_rx_41
Lpre_rw_40:
    v_mov_b32 v4, v72
    v_mov_b32 v5, v73
    v_mov_b32 v6, v74
    v_mov_b32 v7, v75
    v_mov_b32 v8, v76
    v_mov_b32 v9, v77
    v_mov_b32 v10, v78
    v_mov_b32 v11, v79
Lpre_rx_41:
    s_cmp_ge_u32 s6, 4
    s_cbranch_scc1 Lpre_kvw_42
    s_mul_i32 s60, s3, 18432
    v_add_u32 v2, s60, v3
    ds_write_b128 v2, v[80:83] offset:0
    ds_write_b128 v2, v[84:87] offset:1024
    s_cmp_lt_u32 s6, 2
    s_cbranch_scc1 Lpre_kvw_42
    s_lshl_b32 s60, s3, 11
    v_add_u32 v2, s60, v3
    v_add_u32 v2, 143360, v2
    ds_write_b128 v2, v[88:91]
    ds_write_b128 v2, v[92:95] offset:1024
Lpre_kvw_42:
    s_waitcnt lgkmcnt(0)
    s_barrier
    ds_read_b128 v[208:211], v14 offset:0
    ds_read_b128 v[212:215], v14 offset:512
    ds_read_b128 v[216:219], v14 offset:1024
    ds_read_b128 v[220:223], v14 offset:1536
    ds_read_b128 v[224:227], v14 offset:2048
    ds_read_b128 v[228:231], v14 offset:2560
    ds_read_b128 v[232:235], v14 offset:3072
    ds_read_b128 v[236:239], v14 offset:3584
    s_waitcnt lgkmcnt(0)
    s_lshl_b32 s60, s3, 11
    v_add_u32 v0, s60, v3
    s_add_u32 s61, s3, 1
    s_and_b32 s61, s61, 7
    s_lshl_b32 s61, s61, 14
    v_add_u32 v2, s61, v0
    ds_read_b128 v[16:19], v2 offset:0
    ds_read_b128 v[20:23], v2 offset:1024
    s_add_u32 s61, s3, 2
    s_and_b32 s61, s61, 7
    s_lshl_b32 s61, s61, 14
    v_add_u32 v2, s61, v0
    ds_read_b128 v[24:27], v2 offset:0
    ds_read_b128 v[28:31], v2 offset:1024
    s_add_u32 s61, s3, 3
    s_and_b32 s61, s61, 7
    s_lshl_b32 s61, s61, 14
    v_add_u32 v2, s61, v0
    ds_read_b128 v[32:35], v2 offset:0
    ds_read_b128 v[36:39], v2 offset:1024
    s_add_u32 s61, s3, 4
    s_and_b32 s61, s61, 7
    s_lshl_b32 s61, s61, 14
    v_add_u32 v2, s61, v0
    ds_read_b128 v[40:43], v2 offset:0
    ds_read_b128 v[44:47], v2 offset:1024
    s_add_u32 s61, s3, 5
    s_and_b32 s61, s61, 7
    s_lshl_b32 s61, s61, 14
    v_add_u32 v2, s61, v0
    ds_read_b128 v[48:51], v2 offset:0
    ds_read_b128 v[52:55], v2 offset:1024
    s_add_u32 s61, s3, 6
    s_and_b32 s61, s61, 7
    s_lshl_b32 s61, s61, 14
    v_add_u32 v2, s61, v0
    ds_read_b128 v[56:59], v2 offset:0
    ds_read_b128 v[60:63], v2 offset:1024
    s_add_u32 s61, s3, 7
    s_and_b32 s61, s61, 7
    s_lshl_b32 s61, s61, 14
    v_add_u32 v2, s61, v0
    ds_read_b128 v[64:67], v2 offset:0
    ds_read_b128 v[68:71], v2 offset:1024
    v_add_f32 v208, v208, v212
    v_add_f32 v209, v209, v213
    v_add_f32 v210, v210, v214
    v_add_f32 v211, v211, v215
    v_add_f32 v208, v208, v216
    v_add_f32 v209, v209, v217
    v_add_f32 v210, v210, v218
    v_add_f32 v211, v211, v219
    v_add_f32 v208, v208, v220
    v_add_f32 v209, v209, v221
    v_add_f32 v210, v210, v222
    v_add_f32 v211, v211, v223
    v_add_f32 v208, v208, v224
    v_add_f32 v209, v209, v225
    v_add_f32 v210, v210, v226
    v_add_f32 v211, v211, v227
    v_add_f32 v208, v208, v228
    v_add_f32 v209, v209, v229
    v_add_f32 v210, v210, v230
    v_add_f32 v211, v211, v231
    v_add_f32 v208, v208, v232
    v_add_f32 v209, v209, v233
    v_add_f32 v210, v210, v234
    v_add_f32 v211, v211, v235
    v_add_f32 v208, v208, v236
    v_add_f32 v209, v209, v237
    v_add_f32 v210, v210, v238
    v_add_f32 v211, v211, v239
    v_mul_f32 v12, 0x3b000000, v208
    v_mul_f32 v13, 0x3b000000, v209
    v_fma_f32 v13, -v12, v12, v13
    v_max_f32 v13, 0, v13
    v_cvt_pk_bf16_f32 v232, v12, v12
    v_lshlrev_b32 v232, 16, v232
    v_cvt_pk_bf16_f32 v13, v13, v13
    v_lshlrev_b32 v13, 16, v13
    v_add_f32 v13, 0x3727c5ac, v13
    v_cvt_pk_bf16_f32 v13, v13, v13
    v_lshlrev_b32 v13, 16, v13
    v_sqrt_f32 v13, v13
    s_nop 0
    v_cvt_pk_bf16_f32 v13, v13, v13
    v_lshlrev_b32 v13, 16, v13
    v_rcp_f32 v233, v13
    s_nop 0
    v_mul_f32 v12, 0x3b000000, v210
    v_mul_f32 v13, 0x3b000000, v211
    v_fma_f32 v13, -v12, v12, v13
    v_max_f32 v13, 0, v13
    v_cvt_pk_bf16_f32 v234, v12, v12
    v_lshlrev_b32 v234, 16, v234
    v_cvt_pk_bf16_f32 v13, v13, v13
    v_lshlrev_b32 v13, 16, v13
    v_add_f32 v13, 0x3727c5ac, v13
    v_cvt_pk_bf16_f32 v13, v13, v13
    v_lshlrev_b32 v13, 16, v13
    v_sqrt_f32 v13, v13
    s_nop 0
    v_cvt_pk_bf16_f32 v13, v13, v13
    v_lshlrev_b32 v13, 16, v13
    v_rcp_f32 v235, v13
    s_nop 0
    s_waitcnt lgkmcnt(12)
    v_add_f32 v4, v4, v16
    v_add_f32 v5, v5, v17
    v_add_f32 v6, v6, v18
    v_add_f32 v7, v7, v19
    v_add_f32 v8, v8, v20
    v_add_f32 v9, v9, v21
    v_add_f32 v10, v10, v22
    v_add_f32 v11, v11, v23
    s_waitcnt lgkmcnt(10)
    v_add_f32 v4, v4, v24
    v_add_f32 v5, v5, v25
    v_add_f32 v6, v6, v26
    v_add_f32 v7, v7, v27
    v_add_f32 v8, v8, v28
    v_add_f32 v9, v9, v29
    v_add_f32 v10, v10, v30
    v_add_f32 v11, v11, v31
    s_waitcnt lgkmcnt(8)
    v_add_f32 v4, v4, v32
    v_add_f32 v5, v5, v33
    v_add_f32 v6, v6, v34
    v_add_f32 v7, v7, v35
    v_add_f32 v8, v8, v36
    v_add_f32 v9, v9, v37
    v_add_f32 v10, v10, v38
    v_add_f32 v11, v11, v39
    s_waitcnt lgkmcnt(6)
    v_add_f32 v4, v4, v40
    v_add_f32 v5, v5, v41
    v_add_f32 v6, v6, v42
    v_add_f32 v7, v7, v43
    v_add_f32 v8, v8, v44
    v_add_f32 v9, v9, v45
    v_add_f32 v10, v10, v46
    v_add_f32 v11, v11, v47
    s_waitcnt lgkmcnt(4)
    v_add_f32 v4, v4, v48
    v_add_f32 v5, v5, v49
    v_add_f32 v6, v6, v50
    v_add_f32 v7, v7, v51
    v_add_f32 v8, v8, v52
    v_add_f32 v9, v9, v53
    v_add_f32 v10, v10, v54
    v_add_f32 v11, v11, v55
    s_waitcnt lgkmcnt(2)
    v_add_f32 v4, v4, v56
    v_add_f32 v5, v5, v57
    v_add_f32 v6, v6, v58
    v_add_f32 v7, v7, v59
    v_add_f32 v8, v8, v60
    v_add_f32 v9, v9, v61
    v_add_f32 v10, v10, v62
    v_add_f32 v11, v11, v63
    s_waitcnt lgkmcnt(0)
    v_add_f32 v4, v4, v64
    v_add_f32 v5, v5, v65
    v_add_f32 v6, v6, v66
    v_add_f32 v7, v7, v67
    v_add_f32 v8, v8, v68
    v_add_f32 v9, v9, v69
    v_add_f32 v10, v10, v70
    v_add_f32 v11, v11, v71
    s_mov_b32 s21, 0
    s_cmp_ge_u32 s6, 4
    s_cbranch_scc1 Lpre_nk_45
    s_cmp_ge_u32 s3, 2
    s_cbranch_scc1 Lpre_nk_45
    s_and_b32 s7, s6, 1
    s_lshl_b32 s8, s5, 1
    s_add_u32 s8, s8, s7
    s_cmp_eq_u32 s3, 1
    s_cselect_b32 s9, 1, 0
    s_cmp_lt_u32 s6, 2
    s_cselect_b32 s10, 1, 0
    s_and_b32 s10, s10, s9
    s_cmp_lg_u32 s10, 0
    s_cbranch_scc1 Lpre_nk_45
    s_mov_b32 s21, 1
    s_cmp_eq_u32 s3, 1
    s_cbranch_scc1 Lpre_ka_46
    v_add_u32 v2, 0, v3
    s_mov_b32 s11, 18432
    s_branch Lpre_kb_47
Lpre_ka_46:
    v_add_u32 v2, 143360, v3
    s_mov_b32 s11, 2048
Lpre_kb_47:
    ds_read_b128 v[96:99], v2
    ds_read_b128 v[100:103], v2 offset:1024
    v_add_u32 v2, s11, v2
    ds_read_b128 v[104:107], v2
    ds_read_b128 v[108:111], v2 offset:1024
    v_add_u32 v2, s11, v2
    ds_read_b128 v[112:115], v2
    ds_read_b128 v[116:119], v2 offset:1024
    v_add_u32 v2, s11, v2
    ds_read_b128 v[120:123], v2
    ds_read_b128 v[124:127], v2 offset:1024
    v_add_u32 v2, s11, v2
    ds_read_b128 v[128:131], v2
    ds_read_b128 v[132:135], v2 offset:1024
    v_add_u32 v2, s11, v2
    ds_read_b128 v[136:139], v2
    ds_read_b128 v[140:143], v2 offset:1024
    v_add_u32 v2, s11, v2
    ds_read_b128 v[176:179], v2
    ds_read_b128 v[180:183], v2 offset:1024
    v_add_u32 v2, s11, v2
    s_waitcnt lgkmcnt(8)
    ds_read_b128 v[184:187], v2
    ds_read_b128 v[188:191], v2 offset:1024
    v_add_u32 v2, s11, v2
Lpre_nk_45:
    s_lshr_b32 s60, s3, 2
    s_lshl_b32 s60, s60, 7
    s_and_b32 s61, s3, 1
    s_lshl_b32 s61, s61, 6
    s_add_u32 s60, s60, s61
    v_lshrrev_b32 v2, 5, v1
    v_lshlrev_b32 v2, 4, v2
    v_add_u32 v2, 139264, v2
    v_add_u32 v0, s60, v2
    ds_read_b128 v[16:19], v0 offset:0
    ds_read_b128 v[20:23], v0 offset:32
    ds_read_b128 v[24:27], v0 offset:384
    ds_read_b128 v[28:31], v0 offset:416
    ds_read_b128 v[32:35], v0 offset:768
    ds_read_b128 v[36:39], v0 offset:800
    ds_read_b128 v[40:43], v0 offset:1152
    ds_read_b128 v[44:47], v0 offset:1184
    ds_read_b128 v[48:51], v0 offset:1536
    ds_read_b128 v[52:55], v0 offset:1568
    ds_read_b128 v[56:59], v0 offset:1920
    ds_read_b128 v[60:63], v0 offset:1952
    ds_read_b128 v[64:67], v0 offset:2304
    ds_read_b128 v[68:71], v0 offset:2336
    ds_read_b128 v[72:75], v0 offset:2688
    ds_read_b128 v[76:79], v0 offset:2720
    s_waitcnt lgkmcnt(0)
    v_add_f32 v240, v16, v24
    v_add_f32 v241, v17, v25
    v_add_f32 v242, v18, v26
    v_add_f32 v243, v19, v27
    v_add_f32 v244, v20, v28
    v_add_f32 v245, v21, v29
    v_add_f32 v246, v22, v30
    v_add_f32 v247, v23, v31
    v_add_f32 v240, v240, v32
    v_add_f32 v241, v241, v33
    v_add_f32 v242, v242, v34
    v_add_f32 v243, v243, v35
    v_add_f32 v244, v244, v36
    v_add_f32 v245, v245, v37
    v_add_f32 v246, v246, v38
    v_add_f32 v247, v247, v39
    v_add_f32 v240, v240, v40
    v_add_f32 v241, v241, v41
    v_add_f32 v242, v242, v42
    v_add_f32 v243, v243, v43
    v_add_f32 v244, v244, v44
    v_add_f32 v245, v245, v45
    v_add_f32 v246, v246, v46
    v_add_f32 v247, v247, v47
    v_add_f32 v240, v240, v48
    v_add_f32 v241, v241, v49
    v_add_f32 v242, v242, v50
    v_add_f32 v243, v243, v51
    v_add_f32 v244, v244, v52
    v_add_f32 v245, v245, v53
    v_add_f32 v246, v246, v54
    v_add_f32 v247, v247, v55
    v_add_f32 v240, v240, v56
    v_add_f32 v241, v241, v57
    v_add_f32 v242, v242, v58
    v_add_f32 v243, v243, v59
    v_add_f32 v244, v244, v60
    v_add_f32 v245, v245, v61
    v_add_f32 v246, v246, v62
    v_add_f32 v247, v247, v63
    v_add_f32 v240, v240, v64
    v_add_f32 v241, v241, v65
    v_add_f32 v242, v242, v66
    v_add_f32 v243, v243, v67
    v_add_f32 v244, v244, v68
    v_add_f32 v245, v245, v69
    v_add_f32 v246, v246, v70
    v_add_f32 v247, v247, v71
    v_add_f32 v240, v240, v72
    v_add_f32 v241, v241, v73
    v_add_f32 v242, v242, v74
    v_add_f32 v243, v243, v75
    v_add_f32 v244, v244, v76
    v_add_f32 v245, v245, v77
    v_add_f32 v246, v246, v78
    v_add_f32 v247, v247, v79
    v_mov_b32 v12, v232
    v_mov_b32 v13, v233
    s_bitcmp0_b32 s3, 1
    s_cbranch_scc1 Lpre_qt_48
    v_mov_b32 v12, v234
    v_mov_b32 v13, v235
Lpre_qt_48:
    v_mul_f32 v13, 0x3eb8aa3b, v13
    v_fma_f32 v4, -v12, v240, v4
    v_mul_f32 v4, v13, v4
    v_fma_f32 v5, -v12, v241, v5
    v_mul_f32 v5, v13, v5
    v_fma_f32 v6, -v12, v242, v6
    v_mul_f32 v6, v13, v6
    v_fma_f32 v7, -v12, v243, v7
    v_mul_f32 v7, v13, v7
    v_fma_f32 v8, -v12, v244, v8
    v_mul_f32 v8, v13, v8
    v_fma_f32 v9, -v12, v245, v9
    v_mul_f32 v9, v13, v9
    v_fma_f32 v10, -v12, v246, v10
    v_mul_f32 v10, v13, v10
    v_fma_f32 v11, -v12, v247, v11
    v_mul_f32 v11, v13, v11
    v_cvt_pk_bf16_f32 v64, v4, v5
    v_cvt_pk_bf16_f32 v65, v6, v7
    v_cvt_pk_bf16_f32 v66, v8, v9
    v_cvt_pk_bf16_f32 v67, v10, v11
    buffer_store_dwordx4 v[64:67], v3, s[40:43], s58 offen
    s_cmp_eq_u32 s21, 0
    s_cbranch_scc1 Lpre_kvfin_44
    v_lshrrev_b32 v2, 5, v1
    v_lshlrev_b32 v2, 4, v2
    v_add_u32 v2, 139520, v2
    v_and_b32 v0, 15, v1
    v_lshlrev_b32 v0, 2, v0
    v_add_u32 v0, 139520, v0
    s_waitcnt lgkmcnt(0)
    ds_read_b128 v[16:19], v2 offset:0
    ds_read_b128 v[20:23], v2 offset:32
    ds_read_b128 v[24:27], v2 offset:384
    ds_read_b128 v[28:31], v2 offset:416
    ds_read_b128 v[32:35], v2 offset:768
    ds_read_b128 v[36:39], v2 offset:800
    ds_read_b128 v[40:43], v2 offset:1152
    ds_read_b128 v[44:47], v2 offset:1184
    ds_read_b128 v[48:51], v2 offset:1536
    ds_read_b128 v[52:55], v2 offset:1568
    ds_read_b128 v[56:59], v2 offset:1920
    ds_read_b128 v[60:63], v2 offset:1952
    ds_read_b128 v[64:67], v2 offset:2304
    ds_read_b128 v[68:71], v2 offset:2336
    ds_read_b128 v[72:75], v2 offset:2688
    ds_read_b128 v[76:79], v2 offset:2720
    s_waitcnt lgkmcnt(0)
    ds_read_b32 v80, v0 offset:0
    ds_read_b32 v81, v0 offset:384
    ds_read_b32 v82, v0 offset:768
    ds_read_b32 v83, v0 offset:1152
    ds_read_b32 v84, v0 offset:1536
    ds_read_b32 v85, v0 offset:1920
    ds_read_b32 v86, v0 offset:2304
    ds_read_b32 v87, v0 offset:2688
    v_add_f32 v248, v16, v24
    v_add_f32 v249, v17, v25
    v_add_f32 v250, v18, v26
    v_add_f32 v251, v19, v27
    v_add_f32 v252, v20, v28
    v_add_f32 v253, v21, v29
    v_add_f32 v254, v22, v30
    v_add_f32 v255, v23, v31
    v_add_f32 v248, v248, v32
    v_add_f32 v249, v249, v33
    v_add_f32 v250, v250, v34
    v_add_f32 v251, v251, v35
    v_add_f32 v252, v252, v36
    v_add_f32 v253, v253, v37
    v_add_f32 v254, v254, v38
    v_add_f32 v255, v255, v39
    v_add_f32 v248, v248, v40
    v_add_f32 v249, v249, v41
    v_add_f32 v250, v250, v42
    v_add_f32 v251, v251, v43
    v_add_f32 v252, v252, v44
    v_add_f32 v253, v253, v45
    v_add_f32 v254, v254, v46
    v_add_f32 v255, v255, v47
    v_add_f32 v248, v248, v48
    v_add_f32 v249, v249, v49
    v_add_f32 v250, v250, v50
    v_add_f32 v251, v251, v51
    v_add_f32 v252, v252, v52
    v_add_f32 v253, v253, v53
    v_add_f32 v254, v254, v54
    v_add_f32 v255, v255, v55
    v_add_f32 v248, v248, v56
    v_add_f32 v249, v249, v57
    v_add_f32 v250, v250, v58
    v_add_f32 v251, v251, v59
    v_add_f32 v252, v252, v60
    v_add_f32 v253, v253, v61
    v_add_f32 v254, v254, v62
    v_add_f32 v255, v255, v63
    v_add_f32 v248, v248, v64
    v_add_f32 v249, v249, v65
    v_add_f32 v250, v250, v66
    v_add_f32 v251, v251, v67
    v_add_f32 v252, v252, v68
    v_add_f32 v253, v253, v69
    v_add_f32 v254, v254, v70
    v_add_f32 v255, v255, v71
    v_add_f32 v248, v248, v72
    v_add_f32 v249, v249, v73
    v_add_f32 v250, v250, v74
    v_add_f32 v251, v251, v75
    v_add_f32 v252, v252, v76
    v_add_f32 v253, v253, v77
    v_add_f32 v254, v254, v78
    v_add_f32 v255, v255, v79
    s_waitcnt lgkmcnt(0)
    v_add_f32 v15, v80, v81
    v_add_f32 v15, v15, v82
    v_add_f32 v15, v15, v83
    v_add_f32 v15, v15, v84
    v_add_f32 v15, v15, v85
    v_add_f32 v15, v15, v86
    v_add_f32 v15, v15, v87
    s_waitcnt lgkmcnt(0)
    v_add_f32 v144, v96, v104
    v_add_f32 v145, v97, v105
    v_add_f32 v146, v98, v106
    v_add_f32 v147, v99, v107
    v_add_f32 v148, v100, v108
    v_add_f32 v149, v101, v109
    v_add_f32 v150, v102, v110
    v_add_f32 v151, v103, v111
    v_add_f32 v144, v144, v112
    v_add_f32 v145, v145, v113
    v_add_f32 v146, v146, v114
    v_add_f32 v147, v147, v115
    v_add_f32 v148, v148, v116
    v_add_f32 v149, v149, v117
    v_add_f32 v150, v150, v118
    v_add_f32 v151, v151, v119
    v_add_f32 v144, v144, v120
    v_add_f32 v145, v145, v121
    v_add_f32 v146, v146, v122
    v_add_f32 v147, v147, v123
    v_add_f32 v148, v148, v124
    v_add_f32 v149, v149, v125
    v_add_f32 v150, v150, v126
    v_add_f32 v151, v151, v127
    v_add_f32 v144, v144, v128
    v_add_f32 v145, v145, v129
    v_add_f32 v146, v146, v130
    v_add_f32 v147, v147, v131
    v_add_f32 v148, v148, v132
    v_add_f32 v149, v149, v133
    v_add_f32 v150, v150, v134
    v_add_f32 v151, v151, v135
    v_add_f32 v144, v144, v136
    v_add_f32 v145, v145, v137
    v_add_f32 v146, v146, v138
    v_add_f32 v147, v147, v139
    v_add_f32 v148, v148, v140
    v_add_f32 v149, v149, v141
    v_add_f32 v150, v150, v142
    v_add_f32 v151, v151, v143
    v_add_f32 v144, v144, v176
    v_add_f32 v145, v145, v177
    v_add_f32 v146, v146, v178
    v_add_f32 v147, v147, v179
    v_add_f32 v148, v148, v180
    v_add_f32 v149, v149, v181
    v_add_f32 v150, v150, v182
    v_add_f32 v151, v151, v183
    v_add_f32 v144, v144, v184
    v_add_f32 v145, v145, v185
    v_add_f32 v146, v146, v186
    v_add_f32 v147, v147, v187
    v_add_f32 v148, v148, v188
    v_add_f32 v149, v149, v189
    v_add_f32 v150, v150, v190
    v_add_f32 v151, v151, v191
    s_cmp_eq_u32 s7, 0
    s_cbranch_scc1 Lpre_kt_50
    v_mov_b32 v232, v234
    v_mov_b32 v233, v235
Lpre_kt_50:
    s_cmp_ge_u32 s6, 2
    s_cbranch_scc1 Lpre_kvv_49
    v_fma_f32 v144, -v232, v248, v144
    v_mul_f32 v144, v233, v144
    v_fma_f32 v145, -v232, v249, v145
    v_mul_f32 v145, v233, v145
    v_fma_f32 v146, -v232, v250, v146
    v_mul_f32 v146, v233, v146
    v_fma_f32 v147, -v232, v251, v147
    v_mul_f32 v147, v233, v147
    v_fma_f32 v148, -v232, v252, v148
    v_mul_f32 v148, v233, v148
    v_fma_f32 v149, -v232, v253, v149
    v_mul_f32 v149, v233, v149
    v_fma_f32 v150, -v232, v254, v150
    v_mul_f32 v150, v233, v150
    v_fma_f32 v151, -v232, v255, v151
    v_mul_f32 v151, v233, v151
    v_cvt_pk_bf16_f32 v160, v144, v145
    v_cvt_pk_bf16_f32 v161, v146, v147
    v_cvt_pk_bf16_f32 v162, v148, v149
    v_cvt_pk_bf16_f32 v163, v150, v151
    s_lshl_b32 s9, s8, 10
    s_add_u32 s9, s9, 28672
    buffer_store_dwordx4 v[160:163], v3, s[40:43], s9 offen
    v_mov_b32 v8, 0
    v_dot2_f32_bf16 v8, v160, v160, v8
    v_dot2_f32_bf16 v8, v161, v161, v8
    v_dot2_f32_bf16 v8, v162, v162, v8
    v_dot2_f32_bf16 v8, v163, v163, v8
    s_nop 3
    v_mov_b32 v9, v8
    s_nop 1
    v_permlane32_swap_b32 v8, v9
    s_nop 1
    v_add_f32 v8, v8, v9
    s_nop 1
    v_max_f32_dpp v8, v8, v8 row_ror:8 row_mask:0xf bank_mask:0xf
    s_nop 1
    v_max_f32_dpp v8, v8, v8 row_ror:4 row_mask:0xf bank_mask:0xf
    s_nop 1
    v_max_f32_dpp v8, v8, v8 row_ror:2 row_mask:0xf bank_mask:0xf
    s_nop 1
    v_max_f32_dpp v8, v8, v8 row_ror:1 row_mask:0xf bank_mask:0xf
    s_nop 1
    v_mov_b32 v9, v8
    s_nop 1
    v_permlane16_swap_b32 v8, v9
    s_nop 1
    v_max_f32 v8, v8, v9
    s_lshl_b32 s9, s8, 2
    s_add_u32 s9, s9, 24576
    v_mov_b32 v9, 0
    s_mov_b64 exec, 1
    buffer_store_dword v8, v9, s[40:43], s9 offen
    s_mov_b64 exec, -1
    s_branch Lpre_kvfin_44
Lpre_kvv_49:
    s_lshl_b32 s60, s3, 8
    v_and_b32 v4, 31, v1
    v_lshlrev_b32 v4, 2, v4
    v_add_u32 v4, s60, v4
    v_add_u32 v4, 159744, v4
    ds_write_b32 v4, v232
    ds_write_b32 v4, v233 offset:128
    v_lshrrev_b32 v5, 5, v1
    v_lshlrev_b32 v5, 4, v5
    s_lshl_b32 s61, s3, 6
    s_add_u32 s60, s60, s61
    v_add_u32 v5, s60, v5
    v_add_u32 v5, 159744, v5
    ds_read_b128 v[160:163], v5
    ds_read_b128 v[164:167], v5 offset:32
    ds_read_b128 v[168:171], v5 offset:128
    ds_read_b128 v[172:175], v5 offset:160
    s_waitcnt lgkmcnt(0)
    v_fma_f32 v144, -v160, v15, v144
    v_mul_f32 v144, v168, v144
    v_fma_f32 v145, -v161, v15, v145
    v_mul_f32 v145, v169, v145
    v_fma_f32 v146, -v162, v15, v146
    v_mul_f32 v146, v170, v146
    v_fma_f32 v147, -v163, v15, v147
    v_mul_f32 v147, v171, v147
    v_fma_f32 v148, -v164, v15, v148
    v_mul_f32 v148, v172, v148
    v_fma_f32 v149, -v165, v15, v149
    v_mul_f32 v149, v173, v149
    v_fma_f32 v150, -v166, v15, v150
    v_mul_f32 v150, v174, v150
    v_fma_f32 v151, -v167, v15, v151
    v_mul_f32 v151, v175, v151
    v_cvt_pk_bf16_f32 v176, v144, v145
    v_cvt_pk_bf16_f32 v177, v146, v147
    v_cvt_pk_bf16_f32 v178, v148, v149
    v_cvt_pk_bf16_f32 v179, v150, v151
    v_and_b32 v4, 15, v1
    v_lshrrev_b32 v5, 5, v1
    v_lshl_add_u32 v4, v5, 4, v4
    v_lshlrev_b32 v4, 4, v4
    s_lshl_b32 s9, s8, 1
    s_add_u32 s9, s9, s3
    s_mul_i32 s9, s9, 544
    s_add_u32 s9, s9, 94208
    s_mov_b32 s12, 0xffff0000
    s_mov_b32 s13, 0xffff0000
    s_mov_b64 exec, s[12:13]
    buffer_store_dwordx4 v[176:179], v4, s[40:43], s9 offen
    s_mov_b64 exec, 3
    v_cmp_eq_u32 vcc, 0, v1
    v_mov_b32 v180, 0
    v_mov_b32 v181, s50
    s_nop 1
    v_cndmask_b32 v180, v180, v181, vcc
    v_mov_b32 v181, v180
    v_mov_b32 v182, v180
    v_mov_b32 v183, v180
    buffer_store_dwordx4 v[180:183], v3, s[40:43], s9 offen offset:512
    s_mov_b64 exec, -1
Lpre_kvfin_44:
    s_cmp_eq_u32 s59, 0
    s_cbranch_scc1 Lpre_pend_51
    s_cmp_lg_u32 s3, 7
    s_cbranch_scc1 Lpre_pend_51
    v_lshlrev_b32 v2, 2, v1
    v_add_u32 v4, 143360, v2
    ds_read_b32 v16, v4 offset:0
    ds_read_b32 v17, v4 offset:2048
    ds_read_b32 v18, v4 offset:4096
    ds_read_b32 v19, v4 offset:6144
    ds_read_b32 v20, v4 offset:8192
    ds_read_b32 v21, v4 offset:10240
    ds_read_b32 v22, v4 offset:12288
    ds_read_b32 v23, v4 offset:14336
    s_waitcnt lgkmcnt(0)
    v_add_f32 v16, v16, v17
    v_add_f32 v16, v16, v18
    v_add_f32 v16, v16, v19
    v_add_f32 v16, v16, v20
    v_add_f32 v16, v16, v21
    v_add_f32 v16, v16, v22
    v_add_f32 v16, v16, v23
    s_lshl_b32 s60, s4, 2
    s_add_u32 s60, s60, s59
    buffer_store_dword v16, v2, s[40:43], s60 offen
Lpre_pend_51:
pre_kernel_exit:
    s_endpgm
.globl layer1_kernel
.type layer1_kernel,@function
    .p2align 8
layer1_kernel:
    s_mov_b32 s38, 1
    s_mov_b32 s39, 16941056
    s_branch layer_body
    .globl layer0_kernel
    .type layer0_kernel,@function
    .p2align 8
layer0_kernel:
    s_mov_b32 s38, 0
    s_mov_b32 s39, 0
layer_body:
    s_cmp_ge_u32 s2, 256
    s_cbranch_scc1 layer_body_exit
    s_load_dwordx16 s[16:31], s[0:1], 0
    s_load_dwordx4 s[32:35], s[0:1], 64
    s_load_dwordx2 s[36:37], s[0:1], 80
    v_lshrrev_b32 v2, 6, v0
    v_and_b32 v1, 63, v0
    v_readfirstlane_b32 s3, v2
    v_lshlrev_b32 v3, 4, v1
    s_waitcnt lgkmcnt(0)
    s_add_u32 s40, s36, s39
    s_addc_u32 s41, s37, 0
    s_and_b32 s41, s41, 0xffff
    s_sub_u32 s42, 38654976, s39
    s_mov_b32 s43, 0x00020000
    s_and_b32 s60, s2, 7
    s_lshr_b32 s61, s2, 3
    s_lshl_b32 s5, s60, 2
    s_lshr_b32 s62, s61, 3
    s_add_u32 s5, s5, s62
    s_and_b32 s6, s61, 7
    s_mov_b32 s50, 0x3f803f80
    s_lshl_b32 s60, s6, 16
    s_lshl_b32 s61, s3, 12
    s_add_u32 s60, s60, s61
    s_add_u32 s44, s60, 34439168
    s_add_u32 s47, s60, 33882112
    s_min_u32 s51, s3, 6
    s_mul_i32 s60, s6, 7
    s_add_u32 s51, s51, s60
    s_lshl_b32 s45, s51, 15
    s_add_u32 s45, s45, 34963456
    s_mul_i32 s60, s6, 229376
    s_mul_i32 s61, s3, 14336
    s_add_u32 s46, s60, s61
    s_add_u32 s46, s46, 36798464
    s_sub_u32 s44, s44, s39
    s_sub_u32 s45, s45, s39
    s_sub_u32 s46, s46, s39
    s_sub_u32 s47, s47, s39
    s_cmp_eq_u32 s3, 7
    s_cselect_b32 s45, 0x70000000, s45
    s_getreg_b32 s53, hwreg(HW_REG_XCC_ID)
    s_and_b32 s53, s53, 7
    s_lshl_b32 s53, s53, 2
    s_lshl_b32 s54, s5, 7
    s_add_u32 s54, s54, 16384
    s_cmp_lg_u32 s3, 7
    s_cbranch_scc1 Lly_pr_1
    s_lshl_b32 s60, 1, s53
    v_mov_b32 v4, s60
    v_mov_b32 v5, 0
    s_mov_b64 exec, 1
    buffer_atomic_add v4, v5, s[40:43], s54 offen
    s_mov_b64 exec, -1
Lly_pr_1:
    v_lshlrev_b32 v100, 7, v1
    v_mov_b32 v103, 0
    s_and_b32 s7, s3, 1
    s_lshl_b32 s8, s5, 1
    s_add_u32 s8, s8, s7
    s_lshr_b32 s9, s3, 1
    s_lshl_b32 s10, s6, 2
    s_add_u32 s9, s9, s10
    s_lshl_b32 s8, s8, 5
    s_add_u32 s8, s8, s9
    s_lshl_b32 s8, s8, 10
    s_add_u32 s9, s8, 4358144
    s_add_u32 s8, s8, 6455296
    buffer_load_dwordx4 v[16:19], v3, s[40:43], s9 offen
    v_lshlrev_b32 v8, 2, v1
    s_mov_b32 s10, 24576
    buffer_load_dword v9, v8, s[40:43], s10 offen
    s_lshl_b32 s10, s3, 10
    s_add_u32 m0, s10, 0
    s_add_u32 s14, s10, 28672
    buffer_load_dwordx4 v3, s[40:43], s14 offen lds
    s_add_u32 m0, s10, 65536
    s_add_u32 s14, s10, 94208
    buffer_load_dwordx4 v3, s[40:43], s14 offen lds
    s_add_u32 m0, s10, 73728
    s_add_u32 s14, s10, 102400
    buffer_load_dwordx4 v3, s[40:43], s14 offen lds
    s_add_u32 m0, s10, 8192
    s_add_u32 s14, s10, 36864
    buffer_load_dwordx4 v3, s[40:43], s14 offen lds
    s_mov_b32 m0, 81920
    s_mov_b32 s14, 110592
    buffer_load_dwordx4 v3, s[40:43], s14 offen lds
    v_and_b32 v10, 31, v1
    v_lshrrev_b32 v12, 5, v1
    v_lshl_add_u32 v12, v12, 4, v10
    v_lshlrev_b32 v12, 4, v12
    v_mov_b32 v11, 528
    v_cmp_eq_u32 vcc, 16, v10
    v_cmp_eq_u32 s[12:13], 20, v10
    s_or_b64 s[12:13], vcc, s[12:13]
    v_mov_b32 v13, 512
    s_nop 1
    v_cndmask_b32 v11, v11, v13, s[12:13]
    v_cmp_gt_u32 vcc, 16, v10
    s_nop 1
    v_cndmask_b32 v12, v11, v12, vcc
    v_add_u32 v12, 65536, v12
    v_mov_b32 v20, 0
    v_mov_b32 v21, 0
    v_mov_b32 v22, 0
    v_mov_b32 v23, 0
    v_mov_b32 v24, 0
    v_mov_b32 v25, 0
    v_mov_b32 v26, 0
    v_mov_b32 v27, 0
    v_mov_b32 v28, 0
    v_mov_b32 v29, 0
    v_mov_b32 v30, 0
    v_mov_b32 v31, 0
    v_mov_b32 v32, 0
    v_mov_b32 v33, 0
    v_mov_b32 v34, 0
    v_mov_b32 v35, 0
    s_waitcnt vmcnt(5)
    v_mov_b32 v13, 0
    v_dot2_f32_bf16 v13, v16, v16, v13
    v_dot2_f32_bf16 v13, v17, v17, v13
    v_dot2_f32_bf16 v13, v18, v18, v13
    v_dot2_f32_bf16 v13, v19, v19, v13
    v_max_f32_dpp v9, v9, v9 row_ror:8 row_mask:0xf bank_mask:0xf
    s_nop 1
    v_max_f32_dpp v9, v9, v9 row_ror:4 row_mask:0xf bank_mask:0xf
    s_nop 1
    v_max_f32_dpp v9, v9, v9 row_ror:2 row_mask:0xf bank_mask:0xf
    s_nop 1
    v_max_f32_dpp v9, v9, v9 row_ror:1 row_mask:0xf bank_mask:0xf
    v_mov_b32 v14, v13
    v_mov_b32 v10, v9
    s_nop 1
    v_permlane32_swap_b32 v13, v14
    v_permlane16_swap_b32 v9, v10
    s_nop 1
    v_add_f32 v13, v13, v14
    v_max_f32 v9, v9, v10
    v_mov_b32 v10, v9
    s_nop 1
    v_permlane32_swap_b32 v9, v10
    s_nop 1
    v_max_f32 v9, v9, v10
    v_mul_f32 v13, v9, v13
    v_cmp_ge_f32 vcc, 0x45610000, v13
    s_nop 4
    s_cmp_eq_u64 vcc, exec
    s_cselect_b32 s20, 0, 1
    s_waitcnt vmcnt(2)
    s_barrier
    s_cmp_lg_u32 s20, 0
    s_cbranch_scc1 Lly_slow_2
    s_cmp_lt_u32 s3, 4
    s_cbranch_scc1 Lly_pr_4
    s_setprio 1
Lly_pr_4:
    ds_read_b128 v[76:79], v3 offset:0
    ds_read_b128 v[80:83], v3 offset:1024
    ds_read_b128 v[84:87], v12 offset:0
    ds_read_b128 v[88:91], v12 offset:544
    s_waitcnt lgkmcnt(3)
    v_mfma_f32_32x32x16_bf16 v[36:51], v[76:79], v[16:19], 0
    s_nop 11
    v_exp_f32 v36, v36
    v_exp_f32 v37, v37
    v_exp_f32 v38, v38
    v_exp_f32 v39, v39
    v_exp_f32 v40, v40
    v_exp_f32 v41, v41
    v_exp_f32 v42, v42
    v_exp_f32 v43, v43
    s_waitcnt lgkmcnt(2)
    v_cvt_pk_bf16_f32 v68, v36, v37
    v_cvt_pk_bf16_f32 v69, v38, v39
    v_cvt_pk_bf16_f32 v70, v40, v41
    v_cvt_pk_bf16_f32 v71, v42, v43
    v_mfma_f32_32x32x16_bf16 v[52:67], v[80:83], v[16:19], 0
    ds_read_b128 v[76:79], v3 offset:2048
    v_exp_f32 v44, v44
    v_exp_f32 v45, v45
    v_exp_f32 v46, v46
    v_exp_f32 v47, v47
    s_waitcnt lgkmcnt(1)
    v_mfma_f32_32x32x16_bf16 v[20:35], v[84:87], v[68:71], v[20:35]
    v_exp_f32 v48, v48
    v_exp_f32 v49, v49
    v_exp_f32 v50, v50
    v_exp_f32 v51, v51
    s_add_u32 m0, s10, 16384
    s_add_u32 s14, s10, 45056
    buffer_load_dwordx4 v3, s[40:43], s14 offen lds
    s_add_u32 m0, s10, 82944
    s_add_u32 s14, s10, 111616
    buffer_load_dwordx4 v3, s[40:43], s14 offen lds
    s_add_u32 m0, s10, 91136
    s_add_u32 s14, s10, 119808
    buffer_load_dwordx4 v3, s[40:43], s14 offen lds
    v_cvt_pk_bf16_f32 v72, v44, v45
    v_cvt_pk_bf16_f32 v73, v46, v47
    v_cvt_pk_bf16_f32 v74, v48, v49
    v_cvt_pk_bf16_f32 v75, v50, v51
    ds_read_b128 v[92:95], v12 offset:1088
    ds_read_b128 v[96:99], v12 offset:1632
    v_exp_f32 v52, v52
    v_exp_f32 v53, v53
    v_exp_f32 v54, v54
    v_exp_f32 v55, v55
    v_mfma_f32_32x32x16_bf16 v[20:35], v[88:91], v[72:75], v[20:35]
    v_exp_f32 v56, v56
    v_exp_f32 v57, v57
    v_exp_f32 v58, v58
    v_exp_f32 v59, v59
    s_waitcnt lgkmcnt(2)
    v_cvt_pk_bf16_f32 v68, v52, v53
    v_cvt_pk_bf16_f32 v69, v54, v55
    v_cvt_pk_bf16_f32 v70, v56, v57
    v_cvt_pk_bf16_f32 v71, v58, v59
    v_mfma_f32_32x32x16_bf16 v[36:51], v[76:79], v[16:19], 0
    ds_read_b128 v[80:83], v3 offset:3072
    v_exp_f32 v60, v60
    v_exp_f32 v61, v61
    v_exp_f32 v62, v62
    v_exp_f32 v63, v63
    s_waitcnt lgkmcnt(1)
    v_mfma_f32_32x32x16_bf16 v[20:35], v[92:95], v[68:71], v[20:35]
    v_exp_f32 v64, v64
    v_exp_f32 v65, v65
    v_exp_f32 v66, v66
    v_exp_f32 v67, v67
    s_add_u32 m0, s10, 24576
    s_add_u32 s14, s10, 53248
    buffer_load_dwordx4 v3, s[40:43], s14 offen lds
    s_mov_b32 m0, 99328
    s_mov_b32 s14, 128000
    buffer_load_dwordx4 v3, s[40:43], s14 offen lds
    v_cvt_pk_bf16_f32 v72, v60, v61
    v_cvt_pk_bf16_f32 v73, v62, v63
    v_cvt_pk_bf16_f32 v74, v64, v65
    v_cvt_pk_bf16_f32 v75, v66, v67
    ds_read_b128 v[84:87], v12 offset:2176
    ds_read_b128 v[88:91], v12 offset:2720
    v_exp_f32 v36, v36
    v_exp_f32 v37, v37
    v_exp_f32 v38, v38
    v_exp_f32 v39, v39
    v_mfma_f32_32x32x16_bf16 v[20:35], v[96:99], v[72:75], v[20:35]
    v_exp_f32 v40, v40
    v_exp_f32 v41, v41
    v_exp_f32 v42, v42
    v_exp_f32 v43, v43
    s_waitcnt lgkmcnt(2)
    v_cvt_pk_bf16_f32 v68, v36, v37
    v_cvt_pk_bf16_f32 v69, v38, v39
    v_cvt_pk_bf16_f32 v70, v40, v41
    v_cvt_pk_bf16_f32 v71, v42, v43
    v_mfma_f32_32x32x16_bf16 v[52:67], v[80:83], v[16:19], 0
    ds_read_b128 v[76:79], v3 offset:4096
    v_exp_f32 v44, v44
    v_exp_f32 v45, v45
    v_exp_f32 v46, v46
    v_exp_f32 v47, v47
    s_waitcnt lgkmcnt(1)
    v_mfma_f32_32x32x16_bf16 v[20:35], v[84:87], v[68:71], v[20:35]
    v_exp_f32 v48, v48
    v_exp_f32 v49, v49
    v_exp_f32 v50, v50
    v_exp_f32 v51, v51
    s_add_u32 m0, s10, 32768
    s_add_u32 s14, s10, 61440
    buffer_load_dwordx4 v3, s[40:43], s14 offen lds
    s_add_u32 m0, s10, 100352
    s_add_u32 s14, s10, 129024
    buffer_load_dwordx4 v3, s[40:43], s14 offen lds
    s_add_u32 m0, s10, 108544
    s_add_u32 s14, s10, 137216
    buffer_load_dwordx4 v3, s[40:43], s14 offen lds
    v_cvt_pk_bf16_f32 v72, v44, v45
    v_cvt_pk_bf16_f32 v73, v46, v47
    v_cvt_pk_bf16_f32 v74, v48, v49
    v_cvt_pk_bf16_f32 v75, v50, v51
    ds_read_b128 v[92:95], v12 offset:3264
    ds_read_b128 v[96:99], v12 offset:3808
    v_exp_f32 v52, v52
    v_exp_f32 v53, v53
    v_exp_f32 v54, v54
    v_exp_f32 v55, v55
    v_mfma_f32_32x32x16_bf16 v[20:35], v[88:91], v[72:75], v[20:35]
    v_exp_f32 v56, v56
    v_exp_f32 v57, v57
    v_exp_f32 v58, v58
    v_exp_f32 v59, v59
    s_waitcnt lgkmcnt(2)
    v_cvt_pk_bf16_f32 v68, v52, v53
    v_cvt_pk_bf16_f32 v69, v54, v55
    v_cvt_pk_bf16_f32 v70, v56, v57
    v_cvt_pk_bf16_f32 v71, v58, v59
    v_mfma_f32_32x32x16_bf16 v[36:51], v[76:79], v[16:19], 0
    ds_read_b128 v[80:83], v3 offset:5120
    v_exp_f32 v60, v60
    v_exp_f32 v61, v61
    v_exp_f32 v62, v62
    v_exp_f32 v63, v63
    s_waitcnt lgkmcnt(1)
    v_mfma_f32_32x32x16_bf16 v[20:35], v[92:95], v[68:71], v[20:35]
    v_exp_f32 v64, v64
    v_exp_f32 v65, v65
    v_exp_f32 v66, v66
    v_exp_f32 v67, v67
    s_add_u32 m0, s10, 40960
    s_add_u32 s14, s10, 69632
    buffer_load_dwordx4 v3, s[40:43], s14 offen lds
    s_mov_b32 m0, 116736
    s_mov_b32 s14, 145408
    buffer_load_dwordx4 v3, s[40:43], s14 offen lds
    v_cvt_pk_bf16_f32 v72, v60, v61
    v_cvt_pk_bf16_f32 v73, v62, v63
    v_cvt_pk_bf16_f32 v74, v64, v65
    v_cvt_pk_bf16_f32 v75, v66, v67
    ds_read_b128 v[84:87], v12 offset:4352
    ds_read_b128 v[88:91], v12 offset:4896
    v_exp_f32 v36, v36
    v_exp_f32 v37, v37
    v_exp_f32 v38, v38
    v_exp_f32 v39, v39
    v_mfma_f32_32x32x16_bf16 v[20:35], v[96:99], v[72:75], v[20:35]
    v_exp_f32 v40, v40
    v_exp_f32 v41, v41
    v_exp_f32 v42, v42
    v_exp_f32 v43, v43
    s_waitcnt lgkmcnt(2)
    v_cvt_pk_bf16_f32 v68, v36, v37
    v_cvt_pk_bf16_f32 v69, v38, v39
    v_cvt_pk_bf16_f32 v70, v40, v41
    v_cvt_pk_bf16_f32 v71, v42, v43
    v_mfma_f32_32x32x16_bf16 v[52:67], v[80:83], v[16:19], 0
    ds_read_b128 v[76:79], v3 offset:6144
    v_exp_f32 v44, v44
    v_exp_f32 v45, v45
    v_exp_f32 v46, v46
    v_exp_f32 v47, v47
    s_waitcnt lgkmcnt(1)
    v_mfma_f32_32x32x16_bf16 v[20:35], v[84:87], v[68:71], v[20:35]
    v_exp_f32 v48, v48
    v_exp_f32 v49, v49
    v_exp_f32 v50, v50
    v_exp_f32 v51, v51
    s_add_u32 m0, s10, 49152
    s_add_u32 s14, s10, 77824
    buffer_load_dwordx4 v3, s[40:43], s14 offen lds
    s_add_u32 m0, s10, 117760
    s_add_u32 s14, s10, 146432
    buffer_load_dwordx4 v3, s[40:43], s14 offen lds
    s_add_u32 m0, s10, 125952
    s_add_u32 s14, s10, 154624
    buffer_load_dwordx4 v3, s[40:43], s14 offen lds
    v_cvt_pk_bf16_f32 v72, v44, v45
    v_cvt_pk_bf16_f32 v73, v46, v47
    v_cvt_pk_bf16_f32 v74, v48, v49
    v_cvt_pk_bf16_f32 v75, v50, v51
    ds_read_b128 v[92:95], v12 offset:5440
    ds_read_b128 v[96:99], v12 offset:5984
    v_exp_f32 v52, v52
    v_exp_f32 v53, v53
    v_exp_f32 v54, v54
    v_exp_f32 v55, v55
    v_mfma_f32_32x32x16_bf16 v[20:35], v[88:91], v[72:75], v[20:35]
    v_exp_f32 v56, v56
    v_exp_f32 v57, v57
    v_exp_f32 v58, v58
    v_exp_f32 v59, v59
    s_waitcnt lgkmcnt(2)
    v_cvt_pk_bf16_f32 v68, v52, v53
    v_cvt_pk_bf16_f32 v69, v54, v55
    v_cvt_pk_bf16_f32 v70, v56, v57
    v_cvt_pk_bf16_f32 v71, v58, v59
    v_mfma_f32_32x32x16_bf16 v[36:51], v[76:79], v[16:19], 0
    ds_read_b128 v[80:83], v3 offset:7168
    v_exp_f32 v60, v60
    v_exp_f32 v61, v61
    v_exp_f32 v62, v62
    v_exp_f32 v63, v63
    s_waitcnt lgkmcnt(1)
    v_mfma_f32_32x32x16_bf16 v[20:35], v[92:95], v[68:71], v[20:35]
    v_exp_f32 v64, v64
    v_exp_f32 v65, v65
    v_exp_f32 v66, v66
    v_exp_f32 v67, v67
    s_add_u32 m0, s10, 57344
    s_add_u32 s14, s10, 86016
    buffer_load_dwordx4 v3, s[40:43], s14 offen lds
    s_mov_b32 m0, 134144
    s_mov_b32 s14, 162816
    buffer_load_dwordx4 v3, s[40:43], s14 offen lds
    v_cvt_pk_bf16_f32 v72, v60, v61
    v_cvt_pk_bf16_f32 v73, v62, v63
    v_cvt_pk_bf16_f32 v74, v64, v65
    v_cvt_pk_bf16_f32 v75, v66, v67
    ds_read_b128 v[84:87], v12 offset:6528
    ds_read_b128 v[88:91], v12 offset:7072
    v_exp_f32 v36, v36
    v_exp_f32 v37, v37
    v_exp_f32 v38, v38
    v_exp_f32 v39, v39
    v_mfma_f32_32x32x16_bf16 v[20:35], v[96:99], v[72:75], v[20:35]
    v_exp_f32 v40, v40
    v_exp_f32 v41, v41
    v_exp_f32 v42, v42
    v_exp_f32 v43, v43
    s_waitcnt vmcnt(15)
    s_barrier
    s_waitcnt lgkmcnt(2)
    v_cvt_pk_bf16_f32 v68, v36, v37
    v_cvt_pk_bf16_f32 v69, v38, v39
    v_cvt_pk_bf16_f32 v70, v40, v41
    v_cvt_pk_bf16_f32 v71, v42, v43
    v_mfma_f32_32x32x16_bf16 v[52:67], v[80:83], v[16:19], 0
    ds_read_b128 v[76:79], v3 offset:8192
    v_exp_f32 v44, v44
    v_exp_f32 v45, v45
    v_exp_f32 v46, v46
    v_exp_f32 v47, v47
    s_waitcnt lgkmcnt(1)
    v_mfma_f32_32x32x16_bf16 v[20:35], v[84:87], v[68:71], v[20:35]
    v_exp_f32 v48, v48
    v_exp_f32 v49, v49
    v_exp_f32 v50, v50
    v_exp_f32 v51, v51
    buffer_load_dwordx4 v[112:115], v3, s[40:43], s44 offen offset:0
    v_cvt_pk_bf16_f32 v72, v44, v45
    v_cvt_pk_bf16_f32 v73, v46, v47
    v_cvt_pk_bf16_f32 v74, v48, v49
    v_cvt_pk_bf16_f32 v75, v50, v51
    ds_read_b128 v[92:95], v12 offset:7616
    ds_read_b128 v[96:99], v12 offset:8160
    v_exp_f32 v52, v52
    v_exp_f32 v53, v53
    v_exp_f32 v54, v54
    v_exp_f32 v55, v55
    v_mfma_f32_32x32x16_bf16 v[20:35], v[88:91], v[72:75], v[20:35]
    v_exp_f32 v56, v56
    v_exp_f32 v57, v57
    v_exp_f32 v58, v58
    v_exp_f32 v59, v59
    s_waitcnt lgkmcnt(2)
    v_cvt_pk_bf16_f32 v68, v52, v53
    v_cvt_pk_bf16_f32 v69, v54, v55
    v_cvt_pk_bf16_f32 v70, v56, v57
    v_cvt_pk_bf16_f32 v71, v58, v59
    v_mfma_f32_32x32x16_bf16 v[36:51], v[76:79], v[16:19], 0
    ds_read_b128 v[80:83], v3 offset:9216
    v_exp_f32 v60, v60
    v_exp_f32 v61, v61
    v_exp_f32 v62, v62
    v_exp_f32 v63, v63
    s_waitcnt lgkmcnt(1)
    v_mfma_f32_32x32x16_bf16 v[20:35], v[92:95], v[68:71], v[20:35]
    v_exp_f32 v64, v64
    v_exp_f32 v65, v65
    v_exp_f32 v66, v66
    v_exp_f32 v67, v67
    buffer_load_dwordx4 v[116:119], v3, s[40:43], s44 offen offset:1024
    v_cvt_pk_bf16_f32 v72, v60, v61
    v_cvt_pk_bf16_f32 v73, v62, v63
    v_cvt_pk_bf16_f32 v74, v64, v65
    v_cvt_pk_bf16_f32 v75, v66, v67
    ds_read_b128 v[84:87], v12 offset:8704
    ds_read_b128 v[88:91], v12 offset:9248
    v_exp_f32 v36, v36
    v_exp_f32 v37, v37
    v_exp_f32 v38, v38
    v_exp_f32 v39, v39
    v_mfma_f32_32x32x16_bf16 v[20:35], v[96:99], v[72:75], v[20:35]
    v_exp_f32 v40, v40
    v_exp_f32 v41, v41
    v_exp_f32 v42, v42
    v_exp_f32 v43, v43
    s_waitcnt lgkmcnt(2)
    v_cvt_pk_bf16_f32 v68, v36, v37
    v_cvt_pk_bf16_f32 v69, v38, v39
    v_cvt_pk_bf16_f32 v70, v40, v41
    v_cvt_pk_bf16_f32 v71, v42, v43
    v_mfma_f32_32x32x16_bf16 v[52:67], v[80:83], v[16:19], 0
    ds_read_b128 v[76:79], v3 offset:10240
    v_exp_f32 v44, v44
    v_exp_f32 v45, v45
    v_exp_f32 v46, v46
    v_exp_f32 v47, v47
    s_waitcnt lgkmcnt(1)
    v_mfma_f32_32x32x16_bf16 v[20:35], v[84:87], v[68:71], v[20:35]
    v_exp_f32 v48, v48
    v_exp_f32 v49, v49
    v_exp_f32 v50, v50
    v_exp_f32 v51, v51
    buffer_load_dwordx4 v[120:123], v3, s[40:43], s44 offen offset:2048
    v_cvt_pk_bf16_f32 v72, v44, v45
    v_cvt_pk_bf16_f32 v73, v46, v47
    v_cvt_pk_bf16_f32 v74, v48, v49
    v_cvt_pk_bf16_f32 v75, v50, v51
    ds_read_b128 v[92:95], v12 offset:9792
    ds_read_b128 v[96:99], v12 offset:10336
    v_exp_f32 v52, v52
    v_exp_f32 v53, v53
    v_exp_f32 v54, v54
    v_exp_f32 v55, v55
    v_mfma_f32_32x32x16_bf16 v[20:35], v[88:91], v[72:75], v[20:35]
    v_exp_f32 v56, v56
    v_exp_f32 v57, v57
    v_exp_f32 v58, v58
    v_exp_f32 v59, v59
    s_waitcnt lgkmcnt(2)
    v_cvt_pk_bf16_f32 v68, v52, v53
    v_cvt_pk_bf16_f32 v69, v54, v55
    v_cvt_pk_bf16_f32 v70, v56, v57
    v_cvt_pk_bf16_f32 v71, v58, v59
    v_mfma_f32_32x32x16_bf16 v[36:51], v[76:79], v[16:19], 0
    ds_read_b128 v[80:83], v3 offset:11264
    v_exp_f32 v60, v60
    v_exp_f32 v61, v61
    v_exp_f32 v62, v62
    v_exp_f32 v63, v63
    s_waitcnt lgkmcnt(1)
    v_mfma_f32_32x32x16_bf16 v[20:35], v[92:95], v[68:71], v[20:35]
    v_exp_f32 v64, v64
    v_exp_f32 v65, v65
    v_exp_f32 v66, v66
    v_exp_f32 v67, v67
    buffer_load_dwordx4 v[124:127], v3, s[40:43], s44 offen offset:3072
    v_cvt_pk_bf16_f32 v72, v60, v61
    v_cvt_pk_bf16_f32 v73, v62, v63
    v_cvt_pk_bf16_f32 v74, v64, v65
    v_cvt_pk_bf16_f32 v75, v66, v67
    ds_read_b128 v[84:87], v12 offset:10880
    ds_read_b128 v[88:91], v12 offset:11424
    v_exp_f32 v36, v36
    v_exp_f32 v37, v37
    v_exp_f32 v38, v38
    v_exp_f32 v39, v39
    v_mfma_f32_32x32x16_bf16 v[20:35], v[96:99], v[72:75], v[20:35]
    v_exp_f32 v40, v40
    v_exp_f32 v41, v41
    v_exp_f32 v42, v42
    v_exp_f32 v43, v43
    s_waitcnt lgkmcnt(2)
    v_cvt_pk_bf16_f32 v68, v36, v37
    v_cvt_pk_bf16_f32 v69, v38, v39
    v_cvt_pk_bf16_f32 v70, v40, v41
    v_cvt_pk_bf16_f32 v71, v42, v43
    v_mfma_f32_32x32x16_bf16 v[52:67], v[80:83], v[16:19], 0
    ds_read_b128 v[76:79], v3 offset:12288
    v_exp_f32 v44, v44
    v_exp_f32 v45, v45
    v_exp_f32 v46, v46
    v_exp_f32 v47, v47
    s_waitcnt lgkmcnt(1)
    v_mfma_f32_32x32x16_bf16 v[20:35], v[84:87], v[68:71], v[20:35]
    v_exp_f32 v48, v48
    v_exp_f32 v49, v49
    v_exp_f32 v50, v50
    v_exp_f32 v51, v51
    s_add_u32 s60, s44, 32768
    buffer_load_dwordx4 v[128:131], v3, s[40:43], s60 offen offset:0
    v_cvt_pk_bf16_f32 v72, v44, v45
    v_cvt_pk_bf16_f32 v73, v46, v47
    v_cvt_pk_bf16_f32 v74, v48, v49
    v_cvt_pk_bf16_f32 v75, v50, v51
    ds_read_b128 v[92:95], v12 offset:11968
    ds_read_b128 v[96:99], v12 offset:12512
    v_exp_f32 v52, v52
    v_exp_f32 v53, v53
    v_exp_f32 v54, v54
    v_exp_f32 v55, v55
    v_mfma_f32_32x32x16_bf16 v[20:35], v[88:91], v[72:75], v[20:35]
    v_exp_f32 v56, v56
    v_exp_f32 v57, v57
    v_exp_f32 v58, v58
    v_exp_f32 v59, v59
    s_waitcnt lgkmcnt(2)
    v_cvt_pk_bf16_f32 v68, v52, v53
    v_cvt_pk_bf16_f32 v69, v54, v55
    v_cvt_pk_bf16_f32 v70, v56, v57
    v_cvt_pk_bf16_f32 v71, v58, v59
    v_mfma_f32_32x32x16_bf16 v[36:51], v[76:79], v[16:19], 0
    ds_read_b128 v[80:83], v3 offset:13312
    v_exp_f32 v60, v60
    v_exp_f32 v61, v61
    v_exp_f32 v62, v62
    v_exp_f32 v63, v63
    s_waitcnt lgkmcnt(1)
    v_mfma_f32_32x32x16_bf16 v[20:35], v[92:95], v[68:71], v[20:35]
    v_exp_f32 v64, v64
    v_exp_f32 v65, v65
    v_exp_f32 v66, v66
    v_exp_f32 v67, v67
    s_add_u32 s60, s44, 32768
    buffer_load_dwordx4 v[132:135], v3, s[40:43], s60 offen offset:1024
    v_cvt_pk_bf16_f32 v72, v60, v61
    v_cvt_pk_bf16_f32 v73, v62, v63
    v_cvt_pk_bf16_f32 v74, v64, v65
    v_cvt_pk_bf16_f32 v75, v66, v67
    ds_read_b128 v[84:87], v12 offset:13056
    ds_read_b128 v[88:91], v12 offset:13600
    v_exp_f32 v36, v36
    v_exp_f32 v37, v37
    v_exp_f32 v38, v38
    v_exp_f32 v39, v39
    v_mfma_f32_32x32x16_bf16 v[20:35], v[96:99], v[72:75], v[20:35]
    v_exp_f32 v40, v40
    v_exp_f32 v41, v41
    v_exp_f32 v42, v42
    v_exp_f32 v43, v43
    s_waitcnt lgkmcnt(2)
    v_cvt_pk_bf16_f32 v68, v36, v37
    v_cvt_pk_bf16_f32 v69, v38, v39
    v_cvt_pk_bf16_f32 v70, v40, v41
    v_cvt_pk_bf16_f32 v71, v42, v43
    v_mfma_f32_32x32x16_bf16 v[52:67], v[80:83], v[16:19], 0
    ds_read_b128 v[76:79], v3 offset:14336
    v_exp_f32 v44, v44
    v_exp_f32 v45, v45
    v_exp_f32 v46, v46
    v_exp_f32 v47, v47
    s_waitcnt lgkmcnt(1)
    v_mfma_f32_32x32x16_bf16 v[20:35], v[84:87], v[68:71], v[20:35]
    v_exp_f32 v48, v48
    v_exp_f32 v49, v49
    v_exp_f32 v50, v50
    v_exp_f32 v51, v51
    s_add_u32 s60, s44, 32768
    buffer_load_dwordx4 v[136:139], v3, s[40:43], s60 offen offset:2048
    v_cvt_pk_bf16_f32 v72, v44, v45
    v_cvt_pk_bf16_f32 v73, v46, v47
    v_cvt_pk_bf16_f32 v74, v48, v49
    v_cvt_pk_bf16_f32 v75, v50, v51
    ds_read_b128 v[92:95], v12 offset:14144
    ds_read_b128 v[96:99], v12 offset:14688
    v_exp_f32 v52, v52
    v_exp_f32 v53, v53
    v_exp_f32 v54, v54
    v_exp_f32 v55, v55
    v_mfma_f32_32x32x16_bf16 v[20:35], v[88:91], v[72:75], v[20:35]
    v_exp_f32 v56, v56
    v_exp_f32 v57, v57
    v_exp_f32 v58, v58
    v_exp_f32 v59, v59
    s_waitcnt lgkmcnt(2)
    v_cvt_pk_bf16_f32 v68, v52, v53
    v_cvt_pk_bf16_f32 v69, v54, v55
    v_cvt_pk_bf16_f32 v70, v56, v57
    v_cvt_pk_bf16_f32 v71, v58, v59
    v_mfma_f32_32x32x16_bf16 v[36:51], v[76:79], v[16:19], 0
    ds_read_b128 v[80:83], v3 offset:15360
    v_exp_f32 v60, v60
    v_exp_f32 v61, v61
    v_exp_f32 v62, v62
    v_exp_f32 v63, v63
    s_waitcnt lgkmcnt(1)
    v_mfma_f32_32x32x16_bf16 v[20:35], v[92:95], v[68:71], v[20:35]
    v_exp_f32 v64, v64
    v_exp_f32 v65, v65
    v_exp_f32 v66, v66
    v_exp_f32 v67, v67
    s_add_u32 s60, s44, 32768
    buffer_load_dwordx4 v[140:143], v3, s[40:43], s60 offen offset:3072
    v_cvt_pk_bf16_f32 v72, v60, v61
    v_cvt_pk_bf16_f32 v73, v62, v63
    v_cvt_pk_bf16_f32 v74, v64, v65
    v_cvt_pk_bf16_f32 v75, v66, v67
    ds_read_b128 v[84:87], v12 offset:15232
    ds_read_b128 v[88:91], v12 offset:15776
    v_exp_f32 v36, v36
    v_exp_f32 v37, v37
    v_exp_f32 v38, v38
    v_exp_f32 v39, v39
    v_mfma_f32_32x32x16_bf16 v[20:35], v[96:99], v[72:75], v[20:35]
    v_exp_f32 v40, v40
    v_exp_f32 v41, v41
    v_exp_f32 v42, v42
    v_exp_f32 v43, v43
    s_waitcnt vmcnt(8)
    s_barrier
    s_waitcnt lgkmcnt(2)
    v_cvt_pk_bf16_f32 v68, v36, v37
    v_cvt_pk_bf16_f32 v69, v38, v39
    v_cvt_pk_bf16_f32 v70, v40, v41
    v_cvt_pk_bf16_f32 v71, v42, v43
    v_mfma_f32_32x32x16_bf16 v[52:67], v[80:83], v[16:19], 0
    ds_read_b128 v[76:79], v3 offset:16384
    v_exp_f32 v44, v44
    v_exp_f32 v45, v45
    v_exp_f32 v46, v46
    v_exp_f32 v47, v47
    s_waitcnt lgkmcnt(1)
    v_mfma_f32_32x32x16_bf16 v[20:35], v[84:87], v[68:71], v[20:35]
    v_exp_f32 v48, v48
    v_exp_f32 v49, v49
    v_exp_f32 v50, v50
    v_exp_f32 v51, v51
    s_add_u32 s60, s45, 0
    buffer_load_dwordx4 v[144:147], v3, s[40:43], s60 offen offset:0
    v_cvt_pk_bf16_f32 v72, v44, v45
    v_cvt_pk_bf16_f32 v73, v46, v47
    v_cvt_pk_bf16_f32 v74, v48, v49
    v_cvt_pk_bf16_f32 v75, v50, v51
    ds_read_b128 v[92:95], v12 offset:16320
    ds_read_b128 v[96:99], v12 offset:16864
    v_exp_f32 v52, v52
    v_exp_f32 v53, v53
    v_exp_f32 v54, v54
    v_exp_f32 v55, v55
    v_mfma_f32_32x32x16_bf16 v[20:35], v[88:91], v[72:75], v[20:35]
    v_exp_f32 v56, v56
    v_exp_f32 v57, v57
    v_exp_f32 v58, v58
    v_exp_f32 v59, v59
    s_waitcnt lgkmcnt(2)
    v_cvt_pk_bf16_f32 v68, v52, v53
    v_cvt_pk_bf16_f32 v69, v54, v55
    v_cvt_pk_bf16_f32 v70, v56, v57
    v_cvt_pk_bf16_f32 v71, v58, v59
    v_mfma_f32_32x32x16_bf16 v[36:51], v[76:79], v[16:19], 0
    ds_read_b128 v[80:83], v3 offset:17408
    v_exp_f32 v60, v60
    v_exp_f32 v61, v61
    v_exp_f32 v62, v62
    v_exp_f32 v63, v63
    s_waitcnt lgkmcnt(1)
    v_mfma_f32_32x32x16_bf16 v[20:35], v[92:95], v[68:71], v[20:35]
    v_exp_f32 v64, v64
    v_exp_f32 v65, v65
    v_exp_f32 v66, v66
    v_exp_f32 v67, v67
    s_add_u32 s60, s45, 0
    buffer_load_dwordx4 v[148:151], v3, s[40:43], s60 offen offset:1024
    v_cvt_pk_bf16_f32 v72, v60, v61
    v_cvt_pk_bf16_f32 v73, v62, v63
    v_cvt_pk_bf16_f32 v74, v64, v65
    v_cvt_pk_bf16_f32 v75, v66, v67
    v_add_u32 v12, 17408, v12
    ds_read_b128 v[84:87], v12 offset:0
    ds_read_b128 v[88:91], v12 offset:544
    v_exp_f32 v36, v36
    v_exp_f32 v37, v37
    v_exp_f32 v38, v38
    v_exp_f32 v39, v39
    v_mfma_f32_32x32x16_bf16 v[20:35], v[96:99], v[72:75], v[20:35]
    v_exp_f32 v40, v40
    v_exp_f32 v41, v41
    v_exp_f32 v42, v42
    v_exp_f32 v43, v43
    s_waitcnt lgkmcnt(2)
    v_cvt_pk_bf16_f32 v68, v36, v37
    v_cvt_pk_bf16_f32 v69, v38, v39
    v_cvt_pk_bf16_f32 v70, v40, v41
    v_cvt_pk_bf16_f32 v71, v42, v43
    v_mfma_f32_32x32x16_bf16 v[52:67], v[80:83], v[16:19], 0
    ds_read_b128 v[76:79], v3 offset:18432
    v_exp_f32 v44, v44
    v_exp_f32 v45, v45
    v_exp_f32 v46, v46
    v_exp_f32 v47, v47
    s_waitcnt lgkmcnt(1)
    v_mfma_f32_32x32x16_bf16 v[20:35], v[84:87], v[68:71], v[20:35]
    v_exp_f32 v48, v48
    v_exp_f32 v49, v49
    v_exp_f32 v50, v50
    v_exp_f32 v51, v51
    s_add_u32 s60, s45, 0
    buffer_load_dwordx4 v[152:155], v3, s[40:43], s60 offen offset:2048
    v_cvt_pk_bf16_f32 v72, v44, v45
    v_cvt_pk_bf16_f32 v73, v46, v47
    v_cvt_pk_bf16_f32 v74, v48, v49
    v_cvt_pk_bf16_f32 v75, v50, v51
    ds_read_b128 v[92:95], v12 offset:1088
    ds_read_b128 v[96:99], v12 offset:1632
    v_exp_f32 v52, v52
    v_exp_f32 v53, v53
    v_exp_f32 v54, v54
    v_exp_f32 v55, v55
    v_mfma_f32_32x32x16_bf16 v[20:35], v[88:91], v[72:75], v[20:35]
    v_exp_f32 v56, v56
    v_exp_f32 v57, v57
    v_exp_f32 v58, v58
    v_exp_f32 v59, v59
    s_waitcnt lgkmcnt(2)
    v_cvt_pk_bf16_f32 v68, v52, v53
    v_cvt_pk_bf16_f32 v69, v54, v55
    v_cvt_pk_bf16_f32 v70, v56, v57
    v_cvt_pk_bf16_f32 v71, v58, v59
    v_mfma_f32_32x32x16_bf16 v[36:51], v[76:79], v[16:19], 0
    ds_read_b128 v[80:83], v3 offset:19456
    v_exp_f32 v60, v60
    v_exp_f32 v61, v61
    v_exp_f32 v62, v62
    v_exp_f32 v63, v63
    s_waitcnt lgkmcnt(1)
    v_mfma_f32_32x32x16_bf16 v[20:35], v[92:95], v[68:71], v[20:35]
    v_exp_f32 v64, v64
    v_exp_f32 v65, v65
    v_exp_f32 v66, v66
    v_exp_f32 v67, v67
    s_add_u32 s60, s45, 0
    buffer_load_dwordx4 v[156:159], v3, s[40:43], s60 offen offset:3072
    v_cvt_pk_bf16_f32 v72, v60, v61
    v_cvt_pk_bf16_f32 v73, v62, v63
    v_cvt_pk_bf16_f32 v74, v64, v65
    v_cvt_pk_bf16_f32 v75, v66, v67
    ds_read_b128 v[84:87], v12 offset:2176
    ds_read_b128 v[88:91], v12 offset:2720
    v_exp_f32 v36, v36
    v_exp_f32 v37, v37
    v_exp_f32 v38, v38
    v_exp_f32 v39, v39
    v_mfma_f32_32x32x16_bf16 v[20:35], v[96:99], v[72:75], v[20:35]
    v_exp_f32 v40, v40
    v_exp_f32 v41, v41
    v_exp_f32 v42, v42
    v_exp_f32 v43, v43
    s_waitcnt lgkmcnt(2)
    v_cvt_pk_bf16_f32 v68, v36, v37
    v_cvt_pk_bf16_f32 v69, v38, v39
    v_cvt_pk_bf16_f32 v70, v40, v41
    v_cvt_pk_bf16_f32 v71, v42, v43
    v_mfma_f32_32x32x16_bf16 v[52:67], v[80:83], v[16:19], 0
    ds_read_b128 v[76:79], v3 offset:20480
    v_exp_f32 v44, v44
    v_exp_f32 v45, v45
    v_exp_f32 v46, v46
    v_exp_f32 v47, v47
    s_waitcnt lgkmcnt(1)
    v_mfma_f32_32x32x16_bf16 v[20:35], v[84:87], v[68:71], v[20:35]
    v_exp_f32 v48, v48
    v_exp_f32 v49, v49
    v_exp_f32 v50, v50
    v_exp_f32 v51, v51
    s_add_u32 s60, s45, 4096
    buffer_load_dwordx4 v[160:163], v3, s[40:43], s60 offen offset:0
    v_cvt_pk_bf16_f32 v72, v44, v45
    v_cvt_pk_bf16_f32 v73, v46, v47
    v_cvt_pk_bf16_f32 v74, v48, v49
    v_cvt_pk_bf16_f32 v75, v50, v51
    ds_read_b128 v[92:95], v12 offset:3264
    ds_read_b128 v[96:99], v12 offset:3808
    v_exp_f32 v52, v52
    v_exp_f32 v53, v53
    v_exp_f32 v54, v54
    v_exp_f32 v55, v55
    v_mfma_f32_32x32x16_bf16 v[20:35], v[88:91], v[72:75], v[20:35]
    v_exp_f32 v56, v56
    v_exp_f32 v57, v57
    v_exp_f32 v58, v58
    v_exp_f32 v59, v59
    s_waitcnt lgkmcnt(2)
    v_cvt_pk_bf16_f32 v68, v52, v53
    v_cvt_pk_bf16_f32 v69, v54, v55
    v_cvt_pk_bf16_f32 v70, v56, v57
    v_cvt_pk_bf16_f32 v71, v58, v59
    v_mfma_f32_32x32x16_bf16 v[36:51], v[76:79], v[16:19], 0
    ds_read_b128 v[80:83], v3 offset:21504
    v_exp_f32 v60, v60
    v_exp_f32 v61, v61
    v_exp_f32 v62, v62
    v_exp_f32 v63, v63
    s_waitcnt lgkmcnt(1)
    v_mfma_f32_32x32x16_bf16 v[20:35], v[92:95], v[68:71], v[20:35]
    v_exp_f32 v64, v64
    v_exp_f32 v65, v65
    v_exp_f32 v66, v66
    v_exp_f32 v67, v67
    s_add_u32 s60, s45, 4096
    buffer_load_dwordx4 v[164:167], v3, s[40:43], s60 offen offset:1024
    v_cvt_pk_bf16_f32 v72, v60, v61
    v_cvt_pk_bf16_f32 v73, v62, v63
    v_cvt_pk_bf16_f32 v74, v64, v65
    v_cvt_pk_bf16_f32 v75, v66, v67
    ds_read_b128 v[84:87], v12 offset:4352
    ds_read_b128 v[88:91], v12 offset:4896
    v_exp_f32 v36, v36
    v_exp_f32 v37, v37
    v_exp_f32 v38, v38
    v_exp_f32 v39, v39
    v_mfma_f32_32x32x16_bf16 v[20:35], v[96:99], v[72:75], v[20:35]
    v_exp_f32 v40, v40
    v_exp_f32 v41, v41
    v_exp_f32 v42, v42
    v_exp_f32 v43, v43
    s_waitcnt lgkmcnt(2)
    v_cvt_pk_bf16_f32 v68, v36, v37
    v_cvt_pk_bf16_f32 v69, v38, v39
    v_cvt_pk_bf16_f32 v70, v40, v41
    v_cvt_pk_bf16_f32 v71, v42, v43
    v_mfma_f32_32x32x16_bf16 v[52:67], v[80:83], v[16:19], 0
    ds_read_b128 v[76:79], v3 offset:22528
    v_exp_f32 v44, v44
    v_exp_f32 v45, v45
    v_exp_f32 v46, v46
    v_exp_f32 v47, v47
    s_waitcnt lgkmcnt(1)
    v_mfma_f32_32x32x16_bf16 v[20:35], v[84:87], v[68:71], v[20:35]
    v_exp_f32 v48, v48
    v_exp_f32 v49, v49
    v_exp_f32 v50, v50
    v_exp_f32 v51, v51
    s_add_u32 s60, s45, 4096
    buffer_load_dwordx4 v[168:171], v3, s[40:43], s60 offen offset:2048
    v_cvt_pk_bf16_f32 v72, v44, v45
    v_cvt_pk_bf16_f32 v73, v46, v47
    v_cvt_pk_bf16_f32 v74, v48, v49
    v_cvt_pk_bf16_f32 v75, v50, v51
    ds_read_b128 v[92:95], v12 offset:5440
    ds_read_b128 v[96:99], v12 offset:5984
    v_exp_f32 v52, v52
    v_exp_f32 v53, v53
    v_exp_f32 v54, v54
    v_exp_f32 v55, v55
    v_mfma_f32_32x32x16_bf16 v[20:35], v[88:91], v[72:75], v[20:35]
    v_exp_f32 v56, v56
    v_exp_f32 v57, v57
    v_exp_f32 v58, v58
    v_exp_f32 v59, v59
    s_waitcnt lgkmcnt(2)
    v_cvt_pk_bf16_f32 v68, v52, v53
    v_cvt_pk_bf16_f32 v69, v54, v55
    v_cvt_pk_bf16_f32 v70, v56, v57
    v_cvt_pk_bf16_f32 v71, v58, v59
    v_mfma_f32_32x32x16_bf16 v[36:51], v[76:79], v[16:19], 0
    ds_read_b128 v[80:83], v3 offset:23552
    v_exp_f32 v60, v60
    v_exp_f32 v61, v61
    v_exp_f32 v62, v62
    v_exp_f32 v63, v63
    s_waitcnt lgkmcnt(1)
    v_mfma_f32_32x32x16_bf16 v[20:35], v[92:95], v[68:71], v[20:35]
    v_exp_f32 v64, v64
    v_exp_f32 v65, v65
    v_exp_f32 v66, v66
    v_exp_f32 v67, v67
    s_add_u32 s60, s45, 4096
    buffer_load_dwordx4 v[172:175], v3, s[40:43], s60 offen offset:3072
    v_cvt_pk_bf16_f32 v72, v60, v61
    v_cvt_pk_bf16_f32 v73, v62, v63
    v_cvt_pk_bf16_f32 v74, v64, v65
    v_cvt_pk_bf16_f32 v75, v66, v67
    ds_read_b128 v[84:87], v12 offset:6528
    ds_read_b128 v[88:91], v12 offset:7072
    v_exp_f32 v36, v36
    v_exp_f32 v37, v37
    v_exp_f32 v38, v38
    v_exp_f32 v39, v39
    v_mfma_f32_32x32x16_bf16 v[20:35], v[96:99], v[72:75], v[20:35]
    v_exp_f32 v40, v40
    v_exp_f32 v41, v41
    v_exp_f32 v42, v42
    v_exp_f32 v43, v43
    s_waitcnt lgkmcnt(2)
    v_cvt_pk_bf16_f32 v68, v36, v37
    v_cvt_pk_bf16_f32 v69, v38, v39
    v_cvt_pk_bf16_f32 v70, v40, v41
    v_cvt_pk_bf16_f32 v71, v42, v43
    v_mfma_f32_32x32x16_bf16 v[52:67], v[80:83], v[16:19], 0
    ds_read_b128 v[76:79], v3 offset:24576
    v_exp_f32 v44, v44
    v_exp_f32 v45, v45
    v_exp_f32 v46, v46
    v_exp_f32 v47, v47
    s_waitcnt lgkmcnt(1)
    v_mfma_f32_32x32x16_bf16 v[20:35], v[84:87], v[68:71], v[20:35]
    v_exp_f32 v48, v48
    v_exp_f32 v49, v49
    v_exp_f32 v50, v50
    v_exp_f32 v51, v51
    s_add_u32 s60, s45, 8192
    buffer_load_dwordx4 v[176:179], v3, s[40:43], s60 offen offset:0
    v_cvt_pk_bf16_f32 v72, v44, v45
    v_cvt_pk_bf16_f32 v73, v46, v47
    v_cvt_pk_bf16_f32 v74, v48, v49
    v_cvt_pk_bf16_f32 v75, v50, v51
    ds_read_b128 v[92:95], v12 offset:7616
    ds_read_b128 v[96:99], v12 offset:8160
    v_exp_f32 v52, v52
    v_exp_f32 v53, v53
    v_exp_f32 v54, v54
    v_exp_f32 v55, v55
    v_mfma_f32_32x32x16_bf16 v[20:35], v[88:91], v[72:75], v[20:35]
    v_exp_f32 v56, v56
    v_exp_f32 v57, v57
    v_exp_f32 v58, v58
    v_exp_f32 v59, v59
    s_waitcnt lgkmcnt(2)
    v_cvt_pk_bf16_f32 v68, v52, v53
    v_cvt_pk_bf16_f32 v69, v54, v55
    v_cvt_pk_bf16_f32 v70, v56, v57
    v_cvt_pk_bf16_f32 v71, v58, v59
    v_mfma_f32_32x32x16_bf16 v[36:51], v[76:79], v[16:19], 0
    ds_read_b128 v[80:83], v3 offset:25600
    v_exp_f32 v60, v60
    v_exp_f32 v61, v61
    v_exp_f32 v62, v62
    v_exp_f32 v63, v63
    s_waitcnt lgkmcnt(1)
    v_mfma_f32_32x32x16_bf16 v[20:35], v[92:95], v[68:71], v[20:35]
    v_exp_f32 v64, v64
    v_exp_f32 v65, v65
    v_exp_f32 v66, v66
    v_exp_f32 v67, v67
    s_add_u32 s60, s45, 8192
    buffer_load_dwordx4 v[180:183], v3, s[40:43], s60 offen offset:1024
    v_cvt_pk_bf16_f32 v72, v60, v61
    v_cvt_pk_bf16_f32 v73, v62, v63
    v_cvt_pk_bf16_f32 v74, v64, v65
    v_cvt_pk_bf16_f32 v75, v66, v67
    ds_read_b128 v[84:87], v12 offset:8704
    ds_read_b128 v[88:91], v12 offset:9248
    v_exp_f32 v36, v36
    v_exp_f32 v37, v37
    v_exp_f32 v38, v38
    v_exp_f32 v39, v39
    v_mfma_f32_32x32x16_bf16 v[20:35], v[96:99], v[72:75], v[20:35]
    v_exp_f32 v40, v40
    v_exp_f32 v41, v41
    v_exp_f32 v42, v42
    v_exp_f32 v43, v43
    s_waitcnt lgkmcnt(2)
    v_cvt_pk_bf16_f32 v68, v36, v37
    v_cvt_pk_bf16_f32 v69, v38, v39
    v_cvt_pk_bf16_f32 v70, v40, v41
    v_cvt_pk_bf16_f32 v71, v42, v43
    v_mfma_f32_32x32x16_bf16 v[52:67], v[80:83], v[16:19], 0
    ds_read_b128 v[76:79], v3 offset:26624
    v_exp_f32 v44, v44
    v_exp_f32 v45, v45
    v_exp_f32 v46, v46
    v_exp_f32 v47, v47
    s_waitcnt lgkmcnt(1)
    v_mfma_f32_32x32x16_bf16 v[20:35], v[84:87], v[68:71], v[20:35]
    v_exp_f32 v48, v48
    v_exp_f32 v49, v49
    v_exp_f32 v50, v50
    v_exp_f32 v51, v51
    s_add_u32 s60, s45, 8192
    buffer_load_dwordx4 v[184:187], v3, s[40:43], s60 offen offset:2048
    v_cvt_pk_bf16_f32 v72, v44, v45
    v_cvt_pk_bf16_f32 v73, v46, v47
    v_cvt_pk_bf16_f32 v74, v48, v49
    v_cvt_pk_bf16_f32 v75, v50, v51
    ds_read_b128 v[92:95], v12 offset:9792
    ds_read_b128 v[96:99], v12 offset:10336
    v_exp_f32 v52, v52
    v_exp_f32 v53, v53
    v_exp_f32 v54, v54
    v_exp_f32 v55, v55
    v_mfma_f32_32x32x16_bf16 v[20:35], v[88:91], v[72:75], v[20:35]
    v_exp_f32 v56, v56
    v_exp_f32 v57, v57
    v_exp_f32 v58, v58
    v_exp_f32 v59, v59
    s_waitcnt lgkmcnt(2)
    v_cvt_pk_bf16_f32 v68, v52, v53
    v_cvt_pk_bf16_f32 v69, v54, v55
    v_cvt_pk_bf16_f32 v70, v56, v57
    v_cvt_pk_bf16_f32 v71, v58, v59
    v_mfma_f32_32x32x16_bf16 v[36:51], v[76:79], v[16:19], 0
    ds_read_b128 v[80:83], v3 offset:27648
    v_exp_f32 v60, v60
    v_exp_f32 v61, v61
    v_exp_f32 v62, v62
    v_exp_f32 v63, v63
    s_waitcnt lgkmcnt(1)
    v_mfma_f32_32x32x16_bf16 v[20:35], v[92:95], v[68:71], v[20:35]
    v_exp_f32 v64, v64
    v_exp_f32 v65, v65
    v_exp_f32 v66, v66
    v_exp_f32 v67, v67
    s_add_u32 s60, s45, 8192
    buffer_load_dwordx4 v[188:191], v3, s[40:43], s60 offen offset:3072
    v_cvt_pk_bf16_f32 v72, v60, v61
    v_cvt_pk_bf16_f32 v73, v62, v63
    v_cvt_pk_bf16_f32 v74, v64, v65
    v_cvt_pk_bf16_f32 v75, v66, v67
    ds_read_b128 v[84:87], v12 offset:10880
    ds_read_b128 v[88:91], v12 offset:11424
    v_exp_f32 v36, v36
    v_exp_f32 v37, v37
    v_exp_f32 v38, v38
    v_exp_f32 v39, v39
    v_mfma_f32_32x32x16_bf16 v[20:35], v[96:99], v[72:75], v[20:35]
    v_exp_f32 v40, v40
    v_exp_f32 v41, v41
    v_exp_f32 v42, v42
    v_exp_f32 v43, v43
    s_waitcnt lgkmcnt(2)
    v_cvt_pk_bf16_f32 v68, v36, v37
    v_cvt_pk_bf16_f32 v69, v38, v39
    v_cvt_pk_bf16_f32 v70, v40, v41
    v_cvt_pk_bf16_f32 v71, v42, v43
    v_mfma_f32_32x32x16_bf16 v[52:67], v[80:83], v[16:19], 0
    ds_read_b128 v[76:79], v3 offset:28672
    v_exp_f32 v44, v44
    v_exp_f32 v45, v45
    v_exp_f32 v46, v46
    v_exp_f32 v47, v47
    s_waitcnt lgkmcnt(1)
    v_mfma_f32_32x32x16_bf16 v[20:35], v[84:87], v[68:71], v[20:35]
    v_exp_f32 v48, v48
    v_exp_f32 v49, v49
    v_exp_f32 v50, v50
    v_exp_f32 v51, v51
    s_add_u32 s60, s45, 12288
    buffer_load_dwordx4 v[192:195], v3, s[40:43], s60 offen offset:0
    v_cvt_pk_bf16_f32 v72, v44, v45
    v_cvt_pk_bf16_f32 v73, v46, v47
    v_cvt_pk_bf16_f32 v74, v48, v49
    v_cvt_pk_bf16_f32 v75, v50, v51
    ds_read_b128 v[92:95], v12 offset:11968
    ds_read_b128 v[96:99], v12 offset:12512
    v_exp_f32 v52, v52
    v_exp_f32 v53, v53
    v_exp_f32 v54, v54
    v_exp_f32 v55, v55
    v_mfma_f32_32x32x16_bf16 v[20:35], v[88:91], v[72:75], v[20:35]
    v_exp_f32 v56, v56
    v_exp_f32 v57, v57
    v_exp_f32 v58, v58
    v_exp_f32 v59, v59
    s_waitcnt lgkmcnt(2)
    v_cvt_pk_bf16_f32 v68, v52, v53
    v_cvt_pk_bf16_f32 v69, v54, v55
    v_cvt_pk_bf16_f32 v70, v56, v57
    v_cvt_pk_bf16_f32 v71, v58, v59
    v_mfma_f32_32x32x16_bf16 v[36:51], v[76:79], v[16:19], 0
    ds_read_b128 v[80:83], v3 offset:29696
    v_exp_f32 v60, v60
    v_exp_f32 v61, v61
    v_exp_f32 v62, v62
    v_exp_f32 v63, v63
    s_waitcnt lgkmcnt(1)
    v_mfma_f32_32x32x16_bf16 v[20:35], v[92:95], v[68:71], v[20:35]
    v_exp_f32 v64, v64
    v_exp_f32 v65, v65
    v_exp_f32 v66, v66
    v_exp_f32 v67, v67
    s_add_u32 s60, s45, 12288
    buffer_load_dwordx4 v[196:199], v3, s[40:43], s60 offen offset:1024
    v_cvt_pk_bf16_f32 v72, v60, v61
    v_cvt_pk_bf16_f32 v73, v62, v63
    v_cvt_pk_bf16_f32 v74, v64, v65
    v_cvt_pk_bf16_f32 v75, v66, v67
    ds_read_b128 v[84:87], v12 offset:13056
    ds_read_b128 v[88:91], v12 offset:13600
    v_exp_f32 v36, v36
    v_exp_f32 v37, v37
    v_exp_f32 v38, v38
    v_exp_f32 v39, v39
    v_mfma_f32_32x32x16_bf16 v[20:35], v[96:99], v[72:75], v[20:35]
    v_exp_f32 v40, v40
    v_exp_f32 v41, v41
    v_exp_f32 v42, v42
    v_exp_f32 v43, v43
    s_waitcnt lgkmcnt(2)
    v_cvt_pk_bf16_f32 v68, v36, v37
    v_cvt_pk_bf16_f32 v69, v38, v39
    v_cvt_pk_bf16_f32 v70, v40, v41
    v_cvt_pk_bf16_f32 v71, v42, v43
    v_mfma_f32_32x32x16_bf16 v[52:67], v[80:83], v[16:19], 0
    ds_read_b128 v[76:79], v3 offset:30720
    v_exp_f32 v44, v44
    v_exp_f32 v45, v45
    v_exp_f32 v46, v46
    v_exp_f32 v47, v47
    s_waitcnt lgkmcnt(1)
    v_mfma_f32_32x32x16_bf16 v[20:35], v[84:87], v[68:71], v[20:35]
    v_exp_f32 v48, v48
    v_exp_f32 v49, v49
    v_exp_f32 v50, v50
    v_exp_f32 v51, v51
    s_add_u32 s60, s45, 12288
    buffer_load_dwordx4 v[200:203], v3, s[40:43], s60 offen offset:2048
    v_cvt_pk_bf16_f32 v72, v44, v45
    v_cvt_pk_bf16_f32 v73, v46, v47
    v_cvt_pk_bf16_f32 v74, v48, v49
    v_cvt_pk_bf16_f32 v75, v50, v51
    ds_read_b128 v[92:95], v12 offset:14144
    ds_read_b128 v[96:99], v12 offset:14688
    v_exp_f32 v52, v52
    v_exp_f32 v53, v53
    v_exp_f32 v54, v54
    v_exp_f32 v55, v55
    v_mfma_f32_32x32x16_bf16 v[20:35], v[88:91], v[72:75], v[20:35]
    v_exp_f32 v56, v56
    v_exp_f32 v57, v57
    v_exp_f32 v58, v58
    v_exp_f32 v59, v59
    s_waitcnt lgkmcnt(2)
    v_cvt_pk_bf16_f32 v68, v52, v53
    v_cvt_pk_bf16_f32 v69, v54, v55
    v_cvt_pk_bf16_f32 v70, v56, v57
    v_cvt_pk_bf16_f32 v71, v58, v59
    v_mfma_f32_32x32x16_bf16 v[36:51], v[76:79], v[16:19], 0
    ds_read_b128 v[80:83], v3 offset:31744
    v_exp_f32 v60, v60
    v_exp_f32 v61, v61
    v_exp_f32 v62, v62
    v_exp_f32 v63, v63
    s_waitcnt lgkmcnt(1)
    v_mfma_f32_32x32x16_bf16 v[20:35], v[92:95], v[68:71], v[20:35]
    v_exp_f32 v64, v64
    v_exp_f32 v65, v65
    v_exp_f32 v66, v66
    v_exp_f32 v67, v67
    s_add_u32 s60, s45, 12288
    buffer_load_dwordx4 v[204:207], v3, s[40:43], s60 offen offset:3072
    v_cvt_pk_bf16_f32 v72, v60, v61
    v_cvt_pk_bf16_f32 v73, v62, v63
    v_cvt_pk_bf16_f32 v74, v64, v65
    v_cvt_pk_bf16_f32 v75, v66, v67
    ds_read_b128 v[84:87], v12 offset:15232
    ds_read_b128 v[88:91], v12 offset:15776
    v_exp_f32 v36, v36
    v_exp_f32 v37, v37
    v_exp_f32 v38, v38
    v_exp_f32 v39, v39
    v_mfma_f32_32x32x16_bf16 v[20:35], v[96:99], v[72:75], v[20:35]
    v_exp_f32 v40, v40
    v_exp_f32 v41, v41
    v_exp_f32 v42, v42
    v_exp_f32 v43, v43
    s_waitcnt lgkmcnt(2)
    v_cvt_pk_bf16_f32 v68, v36, v37
    v_cvt_pk_bf16_f32 v69, v38, v39
    v_cvt_pk_bf16_f32 v70, v40, v41
    v_cvt_pk_bf16_f32 v71, v42, v43
    v_mfma_f32_32x32x16_bf16 v[52:67], v[80:83], v[16:19], 0
    ds_read_b128 v[76:79], v3 offset:32768
    v_exp_f32 v44, v44
    v_exp_f32 v45, v45
    v_exp_f32 v46, v46
    v_exp_f32 v47, v47
    s_waitcnt lgkmcnt(1)
    v_mfma_f32_32x32x16_bf16 v[20:35], v[84:87], v[68:71], v[20:35]
    v_exp_f32 v48, v48
    v_exp_f32 v49, v49
    v_exp_f32 v50, v50
    v_exp_f32 v51, v51
    s_add_u32 s60, s45, 16384
    buffer_load_dwordx4 v[208:211], v3, s[40:43], s60 offen offset:0
    v_cvt_pk_bf16_f32 v72, v44, v45
    v_cvt_pk_bf16_f32 v73, v46, v47
    v_cvt_pk_bf16_f32 v74, v48, v49
    v_cvt_pk_bf16_f32 v75, v50, v51
    ds_read_b128 v[92:95], v12 offset:16320
    ds_read_b128 v[96:99], v12 offset:16864
    v_exp_f32 v52, v52
    v_exp_f32 v53, v53
    v_exp_f32 v54, v54
    v_exp_f32 v55, v55
    v_mfma_f32_32x32x16_bf16 v[20:35], v[88:91], v[72:75], v[20:35]
    v_exp_f32 v56, v56
    v_exp_f32 v57, v57
    v_exp_f32 v58, v58
    v_exp_f32 v59, v59
    s_waitcnt lgkmcnt(2)
    v_cvt_pk_bf16_f32 v68, v52, v53
    v_cvt_pk_bf16_f32 v69, v54, v55
    v_cvt_pk_bf16_f32 v70, v56, v57
    v_cvt_pk_bf16_f32 v71, v58, v59
    v_mfma_f32_32x32x16_bf16 v[36:51], v[76:79], v[16:19], 0
    ds_read_b128 v[80:83], v3 offset:33792
    v_exp_f32 v60, v60
    v_exp_f32 v61, v61
    v_exp_f32 v62, v62
    v_exp_f32 v63, v63
    s_waitcnt lgkmcnt(1)
    v_mfma_f32_32x32x16_bf16 v[20:35], v[92:95], v[68:71], v[20:35]
    v_exp_f32 v64, v64
    v_exp_f32 v65, v65
    v_exp_f32 v66, v66
    v_exp_f32 v67, v67
    s_add_u32 s60, s45, 16384
    buffer_load_dwordx4 v[212:215], v3, s[40:43], s60 offen offset:1024
    v_cvt_pk_bf16_f32 v72, v60, v61
    v_cvt_pk_bf16_f32 v73, v62, v63
    v_cvt_pk_bf16_f32 v74, v64, v65
    v_cvt_pk_bf16_f32 v75, v66, v67
    v_add_u32 v12, 17408, v12
    ds_read_b128 v[84:87], v12 offset:0
    ds_read_b128 v[88:91], v12 offset:544
    v_exp_f32 v36, v36
    v_exp_f32 v37, v37
    v_exp_f32 v38, v38
    v_exp_f32 v39, v39
    v_mfma_f32_32x32x16_bf16 v[20:35], v[96:99], v[72:75], v[20:35]
    v_exp_f32 v40, v40
    v_exp_f32 v41, v41
    v_exp_f32 v42, v42
    v_exp_f32 v43, v43
    s_waitcnt lgkmcnt(2)
    v_cvt_pk_bf16_f32 v68, v36, v37
    v_cvt_pk_bf16_f32 v69, v38, v39
    v_cvt_pk_bf16_f32 v70, v40, v41
    v_cvt_pk_bf16_f32 v71, v42, v43
    v_mfma_f32_32x32x16_bf16 v[52:67], v[80:83], v[16:19], 0
    ds_read_b128 v[76:79], v3 offset:34816
    v_exp_f32 v44, v44
    v_exp_f32 v45, v45
    v_exp_f32 v46, v46
    v_exp_f32 v47, v47
    s_waitcnt lgkmcnt(1)
    v_mfma_f32_32x32x16_bf16 v[20:35], v[84:87], v[68:71], v[20:35]
    v_exp_f32 v48, v48
    v_exp_f32 v49, v49
    v_exp_f32 v50, v50
    v_exp_f32 v51, v51
    s_add_u32 s60, s45, 16384
    buffer_load_dwordx4 v[216:219], v3, s[40:43], s60 offen offset:2048
    v_cvt_pk_bf16_f32 v72, v44, v45
    v_cvt_pk_bf16_f32 v73, v46, v47
    v_cvt_pk_bf16_f32 v74, v48, v49
    v_cvt_pk_bf16_f32 v75, v50, v51
    ds_read_b128 v[92:95], v12 offset:1088
    ds_read_b128 v[96:99], v12 offset:1632
    v_exp_f32 v52, v52
    v_exp_f32 v53, v53
    v_exp_f32 v54, v54
    v_exp_f32 v55, v55
    v_mfma_f32_32x32x16_bf16 v[20:35], v[88:91], v[72:75], v[20:35]
    v_exp_f32 v56, v56
    v_exp_f32 v57, v57
    v_exp_f32 v58, v58
    v_exp_f32 v59, v59
    s_waitcnt lgkmcnt(2)
    v_cvt_pk_bf16_f32 v68, v52, v53
    v_cvt_pk_bf16_f32 v69, v54, v55
    v_cvt_pk_bf16_f32 v70, v56, v57
    v_cvt_pk_bf16_f32 v71, v58, v59
    v_mfma_f32_32x32x16_bf16 v[36:51], v[76:79], v[16:19], 0
    ds_read_b128 v[80:83], v3 offset:35840
    v_exp_f32 v60, v60
    v_exp_f32 v61, v61
    v_exp_f32 v62, v62
    v_exp_f32 v63, v63
    s_waitcnt lgkmcnt(1)
    v_mfma_f32_32x32x16_bf16 v[20:35], v[92:95], v[68:71], v[20:35]
    v_exp_f32 v64, v64
    v_exp_f32 v65, v65
    v_exp_f32 v66, v66
    v_exp_f32 v67, v67
    s_add_u32 s60, s45, 16384
    buffer_load_dwordx4 v[220:223], v3, s[40:43], s60 offen offset:3072
    v_cvt_pk_bf16_f32 v72, v60, v61
    v_cvt_pk_bf16_f32 v73, v62, v63
    v_cvt_pk_bf16_f32 v74, v64, v65
    v_cvt_pk_bf16_f32 v75, v66, v67
    ds_read_b128 v[84:87], v12 offset:2176
    ds_read_b128 v[88:91], v12 offset:2720
    v_exp_f32 v36, v36
    v_exp_f32 v37, v37
    v_exp_f32 v38, v38
    v_exp_f32 v39, v39
    v_mfma_f32_32x32x16_bf16 v[20:35], v[96:99], v[72:75], v[20:35]
    v_exp_f32 v40, v40
    v_exp_f32 v41, v41
    v_exp_f32 v42, v42
    v_exp_f32 v43, v43
    s_waitcnt lgkmcnt(2)
    v_cvt_pk_bf16_f32 v68, v36, v37
    v_cvt_pk_bf16_f32 v69, v38, v39
    v_cvt_pk_bf16_f32 v70, v40, v41
    v_cvt_pk_bf16_f32 v71, v42, v43
    v_mfma_f32_32x32x16_bf16 v[52:67], v[80:83], v[16:19], 0
    ds_read_b128 v[76:79], v3 offset:36864
    v_exp_f32 v44, v44
    v_exp_f32 v45, v45
    v_exp_f32 v46, v46
    v_exp_f32 v47, v47
    s_waitcnt lgkmcnt(1)
    v_mfma_f32_32x32x16_bf16 v[20:35], v[84:87], v[68:71], v[20:35]
    v_exp_f32 v48, v48
    v_exp_f32 v49, v49
    v_exp_f32 v50, v50
    v_exp_f32 v51, v51
    s_add_u32 s60, s45, 20480
    buffer_load_dwordx4 v[224:227], v3, s[40:43], s60 offen offset:0
    v_cvt_pk_bf16_f32 v72, v44, v45
    v_cvt_pk_bf16_f32 v73, v46, v47
    v_cvt_pk_bf16_f32 v74, v48, v49
    v_cvt_pk_bf16_f32 v75, v50, v51
    ds_read_b128 v[92:95], v12 offset:3264
    ds_read_b128 v[96:99], v12 offset:3808
    v_exp_f32 v52, v52
    v_exp_f32 v53, v53
    v_exp_f32 v54, v54
    v_exp_f32 v55, v55
    v_mfma_f32_32x32x16_bf16 v[20:35], v[88:91], v[72:75], v[20:35]
    v_exp_f32 v56, v56
    v_exp_f32 v57, v57
    v_exp_f32 v58, v58
    v_exp_f32 v59, v59
    s_waitcnt lgkmcnt(2)
    v_cvt_pk_bf16_f32 v68, v52, v53
    v_cvt_pk_bf16_f32 v69, v54, v55
    v_cvt_pk_bf16_f32 v70, v56, v57
    v_cvt_pk_bf16_f32 v71, v58, v59
    v_mfma_f32_32x32x16_bf16 v[36:51], v[76:79], v[16:19], 0
    ds_read_b128 v[80:83], v3 offset:37888
    v_exp_f32 v60, v60
    v_exp_f32 v61, v61
    v_exp_f32 v62, v62
    v_exp_f32 v63, v63
    s_waitcnt lgkmcnt(1)
    v_mfma_f32_32x32x16_bf16 v[20:35], v[92:95], v[68:71], v[20:35]
    v_exp_f32 v64, v64
    v_exp_f32 v65, v65
    v_exp_f32 v66, v66
    v_exp_f32 v67, v67
    s_add_u32 s60, s45, 20480
    buffer_load_dwordx4 v[228:231], v3, s[40:43], s60 offen offset:1024
    v_cvt_pk_bf16_f32 v72, v60, v61
    v_cvt_pk_bf16_f32 v73, v62, v63
    v_cvt_pk_bf16_f32 v74, v64, v65
    v_cvt_pk_bf16_f32 v75, v66, v67
    ds_read_b128 v[84:87], v12 offset:4352
    ds_read_b128 v[88:91], v12 offset:4896
    v_exp_f32 v36, v36
    v_exp_f32 v37, v37
    v_exp_f32 v38, v38
    v_exp_f32 v39, v39
    v_mfma_f32_32x32x16_bf16 v[20:35], v[96:99], v[72:75], v[20:35]
    v_exp_f32 v40, v40
    v_exp_f32 v41, v41
    v_exp_f32 v42, v42
    v_exp_f32 v43, v43
    s_waitcnt lgkmcnt(2)
    v_cvt_pk_bf16_f32 v68, v36, v37
    v_cvt_pk_bf16_f32 v69, v38, v39
    v_cvt_pk_bf16_f32 v70, v40, v41
    v_cvt_pk_bf16_f32 v71, v42, v43
    v_mfma_f32_32x32x16_bf16 v[52:67], v[80:83], v[16:19], 0
    ds_read_b128 v[76:79], v3 offset:38912
    v_exp_f32 v44, v44
    v_exp_f32 v45, v45
    v_exp_f32 v46, v46
    v_exp_f32 v47, v47
    s_waitcnt lgkmcnt(1)
    v_mfma_f32_32x32x16_bf16 v[20:35], v[84:87], v[68:71], v[20:35]
    v_exp_f32 v48, v48
    v_exp_f32 v49, v49
    v_exp_f32 v50, v50
    v_exp_f32 v51, v51
    s_add_u32 s60, s45, 20480
    buffer_load_dwordx4 v[232:235], v3, s[40:43], s60 offen offset:2048
    v_cvt_pk_bf16_f32 v72, v44, v45
    v_cvt_pk_bf16_f32 v73, v46, v47
    v_cvt_pk_bf16_f32 v74, v48, v49
    v_cvt_pk_bf16_f32 v75, v50, v51
    ds_read_b128 v[92:95], v12 offset:5440
    ds_read_b128 v[96:99], v12 offset:5984
    v_exp_f32 v52, v52
    v_exp_f32 v53, v53
    v_exp_f32 v54, v54
    v_exp_f32 v55, v55
    v_mfma_f32_32x32x16_bf16 v[20:35], v[88:91], v[72:75], v[20:35]
    v_exp_f32 v56, v56
    v_exp_f32 v57, v57
    v_exp_f32 v58, v58
    v_exp_f32 v59, v59
    s_waitcnt lgkmcnt(2)
    v_cvt_pk_bf16_f32 v68, v52, v53
    v_cvt_pk_bf16_f32 v69, v54, v55
    v_cvt_pk_bf16_f32 v70, v56, v57
    v_cvt_pk_bf16_f32 v71, v58, v59
    v_mfma_f32_32x32x16_bf16 v[36:51], v[76:79], v[16:19], 0
    ds_read_b128 v[80:83], v3 offset:39936
    v_exp_f32 v60, v60
    v_exp_f32 v61, v61
    v_exp_f32 v62, v62
    v_exp_f32 v63, v63
    s_waitcnt lgkmcnt(1)
    v_mfma_f32_32x32x16_bf16 v[20:35], v[92:95], v[68:71], v[20:35]
    v_exp_f32 v64, v64
    v_exp_f32 v65, v65
    v_exp_f32 v66, v66
    v_exp_f32 v67, v67
    s_add_u32 s60, s45, 20480
    buffer_load_dwordx4 v[236:239], v3, s[40:43], s60 offen offset:3072
    v_cvt_pk_bf16_f32 v72, v60, v61
    v_cvt_pk_bf16_f32 v73, v62, v63
    v_cvt_pk_bf16_f32 v74, v64, v65
    v_cvt_pk_bf16_f32 v75, v66, v67
    ds_read_b128 v[84:87], v12 offset:6528
    ds_read_b128 v[88:91], v12 offset:7072
    v_exp_f32 v36, v36
    v_exp_f32 v37, v37
    v_exp_f32 v38, v38
    v_exp_f32 v39, v39
    v_mfma_f32_32x32x16_bf16 v[20:35], v[96:99], v[72:75], v[20:35]
    v_exp_f32 v40, v40
    v_exp_f32 v41, v41
    v_exp_f32 v42, v42
    v_exp_f32 v43, v43
    s_waitcnt lgkmcnt(2)
    v_cvt_pk_bf16_f32 v68, v36, v37
    v_cvt_pk_bf16_f32 v69, v38, v39
    v_cvt_pk_bf16_f32 v70, v40, v41
    v_cvt_pk_bf16_f32 v71, v42, v43
    v_mfma_f32_32x32x16_bf16 v[52:67], v[80:83], v[16:19], 0
    ds_read_b128 v[76:79], v3 offset:40960
    v_exp_f32 v44, v44
    v_exp_f32 v45, v45
    v_exp_f32 v46, v46
    v_exp_f32 v47, v47
    s_waitcnt lgkmcnt(1)
    v_mfma_f32_32x32x16_bf16 v[20:35], v[84:87], v[68:71], v[20:35]
    v_exp_f32 v48, v48
    v_exp_f32 v49, v49
    v_exp_f32 v50, v50
    v_exp_f32 v51, v51
    s_add_u32 s60, s45, 24576
    buffer_load_dwordx4 v[240:243], v3, s[40:43], s60 offen offset:0
    v_cvt_pk_bf16_f32 v72, v44, v45
    v_cvt_pk_bf16_f32 v73, v46, v47
    v_cvt_pk_bf16_f32 v74, v48, v49
    v_cvt_pk_bf16_f32 v75, v50, v51
    ds_read_b128 v[92:95], v12 offset:7616
    ds_read_b128 v[96:99], v12 offset:8160
    v_exp_f32 v52, v52
    v_exp_f32 v53, v53
    v_exp_f32 v54, v54
    v_exp_f32 v55, v55
    v_mfma_f32_32x32x16_bf16 v[20:35], v[88:91], v[72:75], v[20:35]
    v_exp_f32 v56, v56
    v_exp_f32 v57, v57
    v_exp_f32 v58, v58
    v_exp_f32 v59, v59
    s_waitcnt lgkmcnt(2)
    v_cvt_pk_bf16_f32 v68, v52, v53
    v_cvt_pk_bf16_f32 v69, v54, v55
    v_cvt_pk_bf16_f32 v70, v56, v57
    v_cvt_pk_bf16_f32 v71, v58, v59
    v_mfma_f32_32x32x16_bf16 v[36:51], v[76:79], v[16:19], 0
    ds_read_b128 v[80:83], v3 offset:41984
    v_exp_f32 v60, v60
    v_exp_f32 v61, v61
    v_exp_f32 v62, v62
    v_exp_f32 v63, v63
    s_waitcnt lgkmcnt(1)
    v_mfma_f32_32x32x16_bf16 v[20:35], v[92:95], v[68:71], v[20:35]
    v_exp_f32 v64, v64
    v_exp_f32 v65, v65
    v_exp_f32 v66, v66
    v_exp_f32 v67, v67
    s_add_u32 s60, s45, 24576
    buffer_load_dwordx4 v[244:247], v3, s[40:43], s60 offen offset:1024
    v_cvt_pk_bf16_f32 v72, v60, v61
    v_cvt_pk_bf16_f32 v73, v62, v63
    v_cvt_pk_bf16_f32 v74, v64, v65
    v_cvt_pk_bf16_f32 v75, v66, v67
    ds_read_b128 v[84:87], v12 offset:8704
    ds_read_b128 v[88:91], v12 offset:9248
    v_exp_f32 v36, v36
    v_exp_f32 v37, v37
    v_exp_f32 v38, v38
    v_exp_f32 v39, v39
    v_mfma_f32_32x32x16_bf16 v[20:35], v[96:99], v[72:75], v[20:35]
    v_exp_f32 v40, v40
    v_exp_f32 v41, v41
    v_exp_f32 v42, v42
    v_exp_f32 v43, v43
    s_waitcnt lgkmcnt(2)
    v_cvt_pk_bf16_f32 v68, v36, v37
    v_cvt_pk_bf16_f32 v69, v38, v39
    v_cvt_pk_bf16_f32 v70, v40, v41
    v_cvt_pk_bf16_f32 v71, v42, v43
    v_mfma_f32_32x32x16_bf16 v[52:67], v[80:83], v[16:19], 0
    ds_read_b128 v[76:79], v3 offset:43008
    v_exp_f32 v44, v44
    v_exp_f32 v45, v45
    v_exp_f32 v46, v46
    v_exp_f32 v47, v47
    s_waitcnt lgkmcnt(1)
    v_mfma_f32_32x32x16_bf16 v[20:35], v[84:87], v[68:71], v[20:35]
    v_exp_f32 v48, v48
    v_exp_f32 v49, v49
    v_exp_f32 v50, v50
    v_exp_f32 v51, v51
    s_add_u32 s60, s45, 24576
    buffer_load_dwordx4 v[248:251], v3, s[40:43], s60 offen offset:2048
    v_cvt_pk_bf16_f32 v72, v44, v45
    v_cvt_pk_bf16_f32 v73, v46, v47
    v_cvt_pk_bf16_f32 v74, v48, v49
    v_cvt_pk_bf16_f32 v75, v50, v51
    ds_read_b128 v[92:95], v12 offset:9792
    ds_read_b128 v[96:99], v12 offset:10336
    v_exp_f32 v52, v52
    v_exp_f32 v53, v53
    v_exp_f32 v54, v54
    v_exp_f32 v55, v55
    v_mfma_f32_32x32x16_bf16 v[20:35], v[88:91], v[72:75], v[20:35]
    v_exp_f32 v56, v56
    v_exp_f32 v57, v57
    v_exp_f32 v58, v58
    v_exp_f32 v59, v59
    s_waitcnt lgkmcnt(2)
    v_cvt_pk_bf16_f32 v68, v52, v53
    v_cvt_pk_bf16_f32 v69, v54, v55
    v_cvt_pk_bf16_f32 v70, v56, v57
    v_cvt_pk_bf16_f32 v71, v58, v59
    v_mfma_f32_32x32x16_bf16 v[36:51], v[76:79], v[16:19], 0
    ds_read_b128 v[80:83], v3 offset:44032
    v_exp_f32 v60, v60
    v_exp_f32 v61, v61
    v_exp_f32 v62, v62
    v_exp_f32 v63, v63
    s_waitcnt lgkmcnt(1)
    v_mfma_f32_32x32x16_bf16 v[20:35], v[92:95], v[68:71], v[20:35]
    v_exp_f32 v64, v64
    v_exp_f32 v65, v65
    v_exp_f32 v66, v66
    v_exp_f32 v67, v67
    s_add_u32 s60, s45, 24576
    buffer_load_dwordx4 v[252:255], v3, s[40:43], s60 offen offset:3072
    v_cvt_pk_bf16_f32 v72, v60, v61
    v_cvt_pk_bf16_f32 v73, v62, v63
    v_cvt_pk_bf16_f32 v74, v64, v65
    v_cvt_pk_bf16_f32 v75, v66, v67
    ds_read_b128 v[84:87], v12 offset:10880
    ds_read_b128 v[88:91], v12 offset:11424
    v_exp_f32 v36, v36
    v_exp_f32 v37, v37
    v_exp_f32 v38, v38
    v_exp_f32 v39, v39
    v_mfma_f32_32x32x16_bf16 v[20:35], v[96:99], v[72:75], v[20:35]
    v_exp_f32 v40, v40
    v_exp_f32 v41, v41
    v_exp_f32 v42, v42
    v_exp_f32 v43, v43
    s_waitcnt lgkmcnt(2)
    v_cvt_pk_bf16_f32 v68, v36, v37
    v_cvt_pk_bf16_f32 v69, v38, v39
    v_cvt_pk_bf16_f32 v70, v40, v41
    v_cvt_pk_bf16_f32 v71, v42, v43
    v_mfma_f32_32x32x16_bf16 v[52:67], v[80:83], v[16:19], 0
    ds_read_b128 v[76:79], v3 offset:45056
    v_exp_f32 v44, v44
    v_exp_f32 v45, v45
    v_exp_f32 v46, v46
    v_exp_f32 v47, v47
    s_waitcnt lgkmcnt(1)
    v_mfma_f32_32x32x16_bf16 v[20:35], v[84:87], v[68:71], v[20:35]
    v_exp_f32 v48, v48
    v_exp_f32 v49, v49
    v_exp_f32 v50, v50
    v_exp_f32 v51, v51
    s_add_u32 s60, s45, 28672
    buffer_load_dword v101, v100, s[40:43], s60 offen
    v_cvt_pk_bf16_f32 v72, v44, v45
    v_cvt_pk_bf16_f32 v73, v46, v47
    v_cvt_pk_bf16_f32 v74, v48, v49
    v_cvt_pk_bf16_f32 v75, v50, v51
    ds_read_b128 v[92:95], v12 offset:11968
    ds_read_b128 v[96:99], v12 offset:12512
    v_exp_f32 v52, v52
    v_exp_f32 v53, v53
    v_exp_f32 v54, v54
    v_exp_f32 v55, v55
    v_mfma_f32_32x32x16_bf16 v[20:35], v[88:91], v[72:75], v[20:35]
    v_exp_f32 v56, v56
    v_exp_f32 v57, v57
    v_exp_f32 v58, v58
    v_exp_f32 v59, v59
    s_waitcnt lgkmcnt(2)
    v_cvt_pk_bf16_f32 v68, v52, v53
    v_cvt_pk_bf16_f32 v69, v54, v55
    v_cvt_pk_bf16_f32 v70, v56, v57
    v_cvt_pk_bf16_f32 v71, v58, v59
    v_mfma_f32_32x32x16_bf16 v[36:51], v[76:79], v[16:19], 0
    ds_read_b128 v[80:83], v3 offset:46080
    v_exp_f32 v60, v60
    v_exp_f32 v61, v61
    v_exp_f32 v62, v62
    v_exp_f32 v63, v63
    s_waitcnt lgkmcnt(1)
    v_mfma_f32_32x32x16_bf16 v[20:35], v[92:95], v[68:71], v[20:35]
    v_exp_f32 v64, v64
    v_exp_f32 v65, v65
    v_exp_f32 v66, v66
    v_exp_f32 v67, v67
    s_add_u32 s60, s46, 0
    buffer_load_dword v101, v100, s[40:43], s60 offen
    v_cvt_pk_bf16_f32 v72, v60, v61
    v_cvt_pk_bf16_f32 v73, v62, v63
    v_cvt_pk_bf16_f32 v74, v64, v65
    v_cvt_pk_bf16_f32 v75, v66, v67
    ds_read_b128 v[84:87], v12 offset:13056
    ds_read_b128 v[88:91], v12 offset:13600
    v_exp_f32 v36, v36
    v_exp_f32 v37, v37
    v_exp_f32 v38, v38
    v_exp_f32 v39, v39
    v_mfma_f32_32x32x16_bf16 v[20:35], v[96:99], v[72:75], v[20:35]
    v_exp_f32 v40, v40
    v_exp_f32 v41, v41
    v_exp_f32 v42, v42
    v_exp_f32 v43, v43
    s_waitcnt lgkmcnt(2)
    v_cvt_pk_bf16_f32 v68, v36, v37
    v_cvt_pk_bf16_f32 v69, v38, v39
    v_cvt_pk_bf16_f32 v70, v40, v41
    v_cvt_pk_bf16_f32 v71, v42, v43
    v_mfma_f32_32x32x16_bf16 v[52:67], v[80:83], v[16:19], 0
    ds_read_b128 v[76:79], v3 offset:47104
    v_exp_f32 v44, v44
    v_exp_f32 v45, v45
    v_exp_f32 v46, v46
    v_exp_f32 v47, v47
    s_waitcnt lgkmcnt(1)
    v_mfma_f32_32x32x16_bf16 v[20:35], v[84:87], v[68:71], v[20:35]
    v_exp_f32 v48, v48
    v_exp_f32 v49, v49
    v_exp_f32 v50, v50
    v_exp_f32 v51, v51
    s_add_u32 s60, s46, 8192
    buffer_load_dword v101, v100, s[40:43], s60 offen
    v_cvt_pk_bf16_f32 v72, v44, v45
    v_cvt_pk_bf16_f32 v73, v46, v47
    v_cvt_pk_bf16_f32 v74, v48, v49
    v_cvt_pk_bf16_f32 v75, v50, v51
    ds_read_b128 v[92:95], v12 offset:14144
    ds_read_b128 v[96:99], v12 offset:14688
    v_exp_f32 v52, v52
    v_exp_f32 v53, v53
    v_exp_f32 v54, v54
    v_exp_f32 v55, v55
    v_mfma_f32_32x32x16_bf16 v[20:35], v[88:91], v[72:75], v[20:35]
    v_exp_f32 v56, v56
    v_exp_f32 v57, v57
    v_exp_f32 v58, v58
    v_exp_f32 v59, v59
    s_waitcnt lgkmcnt(2)
    v_cvt_pk_bf16_f32 v68, v52, v53
    v_cvt_pk_bf16_f32 v69, v54, v55
    v_cvt_pk_bf16_f32 v70, v56, v57
    v_cvt_pk_bf16_f32 v71, v58, v59
    v_mfma_f32_32x32x16_bf16 v[36:51], v[76:79], v[16:19], 0
    ds_read_b128 v[80:83], v3 offset:48128
    v_exp_f32 v60, v60
    v_exp_f32 v61, v61
    v_exp_f32 v62, v62
    v_exp_f32 v63, v63
    s_waitcnt lgkmcnt(1)
    v_mfma_f32_32x32x16_bf16 v[20:35], v[92:95], v[68:71], v[20:35]
    v_exp_f32 v64, v64
    v_exp_f32 v65, v65
    v_exp_f32 v66, v66
    v_exp_f32 v67, v67
    s_add_u32 s60, s46, 114688
    buffer_load_dword v101, v100, s[40:43], s60 offen
    v_cvt_pk_bf16_f32 v72, v60, v61
    v_cvt_pk_bf16_f32 v73, v62, v63
    v_cvt_pk_bf16_f32 v74, v64, v65
    v_cvt_pk_bf16_f32 v75, v66, v67
    ds_read_b128 v[84:87], v12 offset:15232
    ds_read_b128 v[88:91], v12 offset:15776
    v_exp_f32 v36, v36
    v_exp_f32 v37, v37
    v_exp_f32 v38, v38
    v_exp_f32 v39, v39
    v_mfma_f32_32x32x16_bf16 v[20:35], v[96:99], v[72:75], v[20:35]
    v_exp_f32 v40, v40
    v_exp_f32 v41, v41
    v_exp_f32 v42, v42
    v_exp_f32 v43, v43
    s_waitcnt lgkmcnt(2)
    v_cvt_pk_bf16_f32 v68, v36, v37
    v_cvt_pk_bf16_f32 v69, v38, v39
    v_cvt_pk_bf16_f32 v70, v40, v41
    v_cvt_pk_bf16_f32 v71, v42, v43
    v_mfma_f32_32x32x16_bf16 v[52:67], v[80:83], v[16:19], 0
    ds_read_b128 v[76:79], v3 offset:49152
    v_exp_f32 v44, v44
    v_exp_f32 v45, v45
    v_exp_f32 v46, v46
    v_exp_f32 v47, v47
    s_waitcnt lgkmcnt(1)
    v_mfma_f32_32x32x16_bf16 v[20:35], v[84:87], v[68:71], v[20:35]
    v_exp_f32 v48, v48
    v_exp_f32 v49, v49
    v_exp_f32 v50, v50
    v_exp_f32 v51, v51
    s_add_u32 s60, s46, 122880
    buffer_load_dword v101, v100, s[40:43], s60 offen
    v_cvt_pk_bf16_f32 v72, v44, v45
    v_cvt_pk_bf16_f32 v73, v46, v47
    v_cvt_pk_bf16_f32 v74, v48, v49
    v_cvt_pk_bf16_f32 v75, v50, v51
    ds_read_b128 v[92:95], v12 offset:16320
    ds_read_b128 v[96:99], v12 offset:16864
    v_exp_f32 v52, v52
    v_exp_f32 v53, v53
    v_exp_f32 v54, v54
    v_exp_f32 v55, v55
    v_mfma_f32_32x32x16_bf16 v[20:35], v[88:91], v[72:75], v[20:35]
    v_exp_f32 v56, v56
    v_exp_f32 v57, v57
    v_exp_f32 v58, v58
    v_exp_f32 v59, v59
    s_waitcnt lgkmcnt(2)
    v_cvt_pk_bf16_f32 v68, v52, v53
    v_cvt_pk_bf16_f32 v69, v54, v55
    v_cvt_pk_bf16_f32 v70, v56, v57
    v_cvt_pk_bf16_f32 v71, v58, v59
    v_mfma_f32_32x32x16_bf16 v[36:51], v[76:79], v[16:19], 0
    ds_read_b128 v[80:83], v3 offset:50176
    v_exp_f32 v60, v60
    v_exp_f32 v61, v61
    v_exp_f32 v62, v62
    v_exp_f32 v63, v63
    s_waitcnt lgkmcnt(1)
    v_mfma_f32_32x32x16_bf16 v[20:35], v[92:95], v[68:71], v[20:35]
    v_exp_f32 v64, v64
    v_exp_f32 v65, v65
    v_exp_f32 v66, v66
    v_exp_f32 v67, v67
    s_add_u32 s60, s47, 0
    buffer_load_dword v101, v100, s[40:43], s60 offen
    v_cvt_pk_bf16_f32 v72, v60, v61
    v_cvt_pk_bf16_f32 v73, v62, v63
    v_cvt_pk_bf16_f32 v74, v64, v65
    v_cvt_pk_bf16_f32 v75, v66, v67
    v_add_u32 v12, 17408, v12
    ds_read_b128 v[84:87], v12 offset:0
    ds_read_b128 v[88:91], v12 offset:544
    v_exp_f32 v36, v36
    v_exp_f32 v37, v37
    v_exp_f32 v38, v38
    v_exp_f32 v39, v39
    v_mfma_f32_32x32x16_bf16 v[20:35], v[96:99], v[72:75], v[20:35]
    v_exp_f32 v40, v40
    v_exp_f32 v41, v41
    v_exp_f32 v42, v42
    v_exp_f32 v43, v43
    s_waitcnt lgkmcnt(2)
    v_cvt_pk_bf16_f32 v68, v36, v37
    v_cvt_pk_bf16_f32 v69, v38, v39
    v_cvt_pk_bf16_f32 v70, v40, v41
    v_cvt_pk_bf16_f32 v71, v42, v43
    v_mfma_f32_32x32x16_bf16 v[52:67], v[80:83], v[16:19], 0
    ds_read_b128 v[76:79], v3 offset:51200
    v_exp_f32 v44, v44
    v_exp_f32 v45, v45
    v_exp_f32 v46, v46
    v_exp_f32 v47, v47
    s_waitcnt lgkmcnt(1)
    v_mfma_f32_32x32x16_bf16 v[20:35], v[84:87], v[68:71], v[20:35]
    v_exp_f32 v48, v48
    v_exp_f32 v49, v49
    v_exp_f32 v50, v50
    v_exp_f32 v51, v51
    s_add_u32 s60, s47, 32768
    buffer_load_dword v101, v100, s[40:43], s60 offen
    v_cvt_pk_bf16_f32 v72, v44, v45
    v_cvt_pk_bf16_f32 v73, v46, v47
    v_cvt_pk_bf16_f32 v74, v48, v49
    v_cvt_pk_bf16_f32 v75, v50, v51
    ds_read_b128 v[92:95], v12 offset:1088
    ds_read_b128 v[96:99], v12 offset:1632
    v_exp_f32 v52, v52
    v_exp_f32 v53, v53
    v_exp_f32 v54, v54
    v_exp_f32 v55, v55
    v_mfma_f32_32x32x16_bf16 v[20:35], v[88:91], v[72:75], v[20:35]
    v_exp_f32 v56, v56
    v_exp_f32 v57, v57
    v_exp_f32 v58, v58
    v_exp_f32 v59, v59
    s_waitcnt lgkmcnt(2)
    v_cvt_pk_bf16_f32 v68, v52, v53
    v_cvt_pk_bf16_f32 v69, v54, v55
    v_cvt_pk_bf16_f32 v70, v56, v57
    v_cvt_pk_bf16_f32 v71, v58, v59
    v_mfma_f32_32x32x16_bf16 v[36:51], v[76:79], v[16:19], 0
    ds_read_b128 v[80:83], v3 offset:52224
    v_exp_f32 v60, v60
    v_exp_f32 v61, v61
    v_exp_f32 v62, v62
    v_exp_f32 v63, v63
    s_waitcnt lgkmcnt(1)
    v_mfma_f32_32x32x16_bf16 v[20:35], v[92:95], v[68:71], v[20:35]
    v_exp_f32 v64, v64
    v_exp_f32 v65, v65
    v_exp_f32 v66, v66
    v_exp_f32 v67, v67
    buffer_load_dword v102, v103, s[40:43], s54 offen sc1
    v_cvt_pk_bf16_f32 v72, v60, v61
    v_cvt_pk_bf16_f32 v73, v62, v63
    v_cvt_pk_bf16_f32 v74, v64, v65
    v_cvt_pk_bf16_f32 v75, v66, v67
    ds_read_b128 v[84:87], v12 offset:2176
    ds_read_b128 v[88:91], v12 offset:2720
    v_exp_f32 v36, v36
    v_exp_f32 v37, v37
    v_exp_f32 v38, v38
    v_exp_f32 v39, v39
    v_mfma_f32_32x32x16_bf16 v[20:35], v[96:99], v[72:75], v[20:35]
    v_exp_f32 v40, v40
    v_exp_f32 v41, v41
    v_exp_f32 v42, v42
    v_exp_f32 v43, v43
    s_waitcnt lgkmcnt(2)
    v_cvt_pk_bf16_f32 v68, v36, v37
    v_cvt_pk_bf16_f32 v69, v38, v39
    v_cvt_pk_bf16_f32 v70, v40, v41
    v_cvt_pk_bf16_f32 v71, v42, v43
    v_mfma_f32_32x32x16_bf16 v[52:67], v[80:83], v[16:19], 0
    ds_read_b128 v[76:79], v3 offset:53248
    v_exp_f32 v44, v44
    v_exp_f32 v45, v45
    v_exp_f32 v46, v46
    v_exp_f32 v47, v47
    s_waitcnt lgkmcnt(1)
    v_mfma_f32_32x32x16_bf16 v[20:35], v[84:87], v[68:71], v[20:35]
    v_exp_f32 v48, v48
    v_exp_f32 v49, v49
    v_exp_f32 v50, v50
    v_exp_f32 v51, v51
    s_nop 0
    v_cvt_pk_bf16_f32 v72, v44, v45
    v_cvt_pk_bf16_f32 v73, v46, v47
    v_cvt_pk_bf16_f32 v74, v48, v49
    v_cvt_pk_bf16_f32 v75, v50, v51
    ds_read_b128 v[92:95], v12 offset:3264
    ds_read_b128 v[96:99], v12 offset:3808
    v_exp_f32 v52, v52
    v_exp_f32 v53, v53
    v_exp_f32 v54, v54
    v_exp_f32 v55, v55
    v_mfma_f32_32x32x16_bf16 v[20:35], v[88:91], v[72:75], v[20:35]
    v_exp_f32 v56, v56
    v_exp_f32 v57, v57
    v_exp_f32 v58, v58
    v_exp_f32 v59, v59
    s_waitcnt lgkmcnt(2)
    v_cvt_pk_bf16_f32 v68, v52, v53
    v_cvt_pk_bf16_f32 v69, v54, v55
    v_cvt_pk_bf16_f32 v70, v56, v57
    v_cvt_pk_bf16_f32 v71, v58, v59
    v_mfma_f32_32x32x16_bf16 v[36:51], v[76:79], v[16:19], 0
    ds_read_b128 v[80:83], v3 offset:54272
    v_exp_f32 v60, v60
    v_exp_f32 v61, v61
    v_exp_f32 v62, v62
    v_exp_f32 v63, v63
    s_waitcnt lgkmcnt(1)
    v_mfma_f32_32x32x16_bf16 v[20:35], v[92:95], v[68:71], v[20:35]
    v_exp_f32 v64, v64
    v_exp_f32 v65, v65
    v_exp_f32 v66, v66
    v_exp_f32 v67, v67
    s_nop 0
    v_cvt_pk_bf16_f32 v72, v60, v61
    v_cvt_pk_bf16_f32 v73, v62, v63
    v_cvt_pk_bf16_f32 v74, v64, v65
    v_cvt_pk_bf16_f32 v75, v66, v67
    ds_read_b128 v[84:87], v12 offset:4352
    ds_read_b128 v[88:91], v12 offset:4896
    v_exp_f32 v36, v36
    v_exp_f32 v37, v37
    v_exp_f32 v38, v38
    v_exp_f32 v39, v39
    v_mfma_f32_32x32x16_bf16 v[20:35], v[96:99], v[72:75], v[20:35]
    v_exp_f32 v40, v40
    v_exp_f32 v41, v41
    v_exp_f32 v42, v42
    v_exp_f32 v43, v43
    s_waitcnt lgkmcnt(2)
    v_cvt_pk_bf16_f32 v68, v36, v37
    v_cvt_pk_bf16_f32 v69, v38, v39
    v_cvt_pk_bf16_f32 v70, v40, v41
    v_cvt_pk_bf16_f32 v71, v42, v43
    v_mfma_f32_32x32x16_bf16 v[52:67], v[80:83], v[16:19], 0
    ds_read_b128 v[76:79], v3 offset:55296
    v_exp_f32 v44, v44
    v_exp_f32 v45, v45
    v_exp_f32 v46, v46
    v_exp_f32 v47, v47
    s_waitcnt lgkmcnt(1)
    v_mfma_f32_32x32x16_bf16 v[20:35], v[84:87], v[68:71], v[20:35]
    v_exp_f32 v48, v48
    v_exp_f32 v49, v49
    v_exp_f32 v50, v50
    v_exp_f32 v51, v51
    s_nop 0
    v_cvt_pk_bf16_f32 v72, v44, v45
    v_cvt_pk_bf16_f32 v73, v46, v47
    v_cvt_pk_bf16_f32 v74, v48, v49
    v_cvt_pk_bf16_f32 v75, v50, v51
    ds_read_b128 v[92:95], v12 offset:5440
    ds_read_b128 v[96:99], v12 offset:5984
    v_exp_f32 v52, v52
    v_exp_f32 v53, v53
    v_exp_f32 v54, v54
    v_exp_f32 v55, v55
    v_mfma_f32_32x32x16_bf16 v[20:35], v[88:91], v[72:75], v[20:35]
    v_exp_f32 v56, v56
    v_exp_f32 v57, v57
    v_exp_f32 v58, v58
    v_exp_f32 v59, v59
    s_waitcnt lgkmcnt(2)
    v_cvt_pk_bf16_f32 v68, v52, v53
    v_cvt_pk_bf16_f32 v69, v54, v55
    v_cvt_pk_bf16_f32 v70, v56, v57
    v_cvt_pk_bf16_f32 v71, v58, v59
    v_mfma_f32_32x32x16_bf16 v[36:51], v[76:79], v[16:19], 0
    ds_read_b128 v[80:83], v3 offset:56320
    v_exp_f32 v60, v60
    v_exp_f32 v61, v61
    v_exp_f32 v62, v62
    v_exp_f32 v63, v63
    s_waitcnt lgkmcnt(1)
    v_mfma_f32_32x32x16_bf16 v[20:35], v[92:95], v[68:71], v[20:35]
    v_exp_f32 v64, v64
    v_exp_f32 v65, v65
    v_exp_f32 v66, v66
    v_exp_f32 v67, v67
    s_nop 0
    v_cvt_pk_bf16_f32 v72, v60, v61
    v_cvt_pk_bf16_f32 v73, v62, v63
    v_cvt_pk_bf16_f32 v74, v64, v65
    v_cvt_pk_bf16_f32 v75, v66, v67
    ds_read_b128 v[84:87], v12 offset:6528
    ds_read_b128 v[88:91], v12 offset:7072
    v_exp_f32 v36, v36
    v_exp_f32 v37, v37
    v_exp_f32 v38, v38
    v_exp_f32 v39, v39
    v_mfma_f32_32x32x16_bf16 v[20:35], v[96:99], v[72:75], v[20:35]
    v_exp_f32 v40, v40
    v_exp_f32 v41, v41
    v_exp_f32 v42, v42
    v_exp_f32 v43, v43
    s_waitcnt lgkmcnt(2)
    v_cvt_pk_bf16_f32 v68, v36, v37
    v_cvt_pk_bf16_f32 v69, v38, v39
    v_cvt_pk_bf16_f32 v70, v40, v41
    v_cvt_pk_bf16_f32 v71, v42, v43
    v_mfma_f32_32x32x16_bf16 v[52:67], v[80:83], v[16:19], 0
    ds_read_b128 v[76:79], v3 offset:57344
    v_exp_f32 v44, v44
    v_exp_f32 v45, v45
    v_exp_f32 v46, v46
    v_exp_f32 v47, v47
    s_waitcnt lgkmcnt(1)
    v_mfma_f32_32x32x16_bf16 v[20:35], v[84:87], v[68:71], v[20:35]
    v_exp_f32 v48, v48
    v_exp_f32 v49, v49
    v_exp_f32 v50, v50
    v_exp_f32 v51, v51
    s_nop 0
    v_cvt_pk_bf16_f32 v72, v44, v45
    v_cvt_pk_bf16_f32 v73, v46, v47
    v_cvt_pk_bf16_f32 v74, v48, v49
    v_cvt_pk_bf16_f32 v75, v50, v51
    ds_read_b128 v[92:95], v12 offset:7616
    ds_read_b128 v[96:99], v12 offset:8160
    v_exp_f32 v52, v52
    v_exp_f32 v53, v53
    v_exp_f32 v54, v54
    v_exp_f32 v55, v55
    v_mfma_f32_32x32x16_bf16 v[20:35], v[88:91], v[72:75], v[20:35]
    v_exp_f32 v56, v56
    v_exp_f32 v57, v57
    v_exp_f32 v58, v58
    v_exp_f32 v59, v59
    s_waitcnt lgkmcnt(2)
    v_cvt_pk_bf16_f32 v68, v52, v53
    v_cvt_pk_bf16_f32 v69, v54, v55
    v_cvt_pk_bf16_f32 v70, v56, v57
    v_cvt_pk_bf16_f32 v71, v58, v59
    v_mfma_f32_32x32x16_bf16 v[36:51], v[76:79], v[16:19], 0
    ds_read_b128 v[80:83], v3 offset:58368
    v_exp_f32 v60, v60
    v_exp_f32 v61, v61
    v_exp_f32 v62, v62
    v_exp_f32 v63, v63
    s_waitcnt lgkmcnt(1)
    v_mfma_f32_32x32x16_bf16 v[20:35], v[92:95], v[68:71], v[20:35]
    v_exp_f32 v64, v64
    v_exp_f32 v65, v65
    v_exp_f32 v66, v66
    v_exp_f32 v67, v67
    s_nop 0
    v_cvt_pk_bf16_f32 v72, v60, v61
    v_cvt_pk_bf16_f32 v73, v62, v63
    v_cvt_pk_bf16_f32 v74, v64, v65
    v_cvt_pk_bf16_f32 v75, v66, v67
    ds_read_b128 v[84:87], v12 offset:8704
    ds_read_b128 v[88:91], v12 offset:9248
    v_exp_f32 v36, v36
    v_exp_f32 v37, v37
    v_exp_f32 v38, v38
    v_exp_f32 v39, v39
    v_mfma_f32_32x32x16_bf16 v[20:35], v[96:99], v[72:75], v[20:35]
    v_exp_f32 v40, v40
    v_exp_f32 v41, v41
    v_exp_f32 v42, v42
    v_exp_f32 v43, v43
    s_waitcnt lgkmcnt(2)
    v_cvt_pk_bf16_f32 v68, v36, v37
    v_cvt_pk_bf16_f32 v69, v38, v39
    v_cvt_pk_bf16_f32 v70, v40, v41
    v_cvt_pk_bf16_f32 v71, v42, v43
    v_mfma_f32_32x32x16_bf16 v[52:67], v[80:83], v[16:19], 0
    ds_read_b128 v[76:79], v3 offset:59392
    v_exp_f32 v44, v44
    v_exp_f32 v45, v45
    v_exp_f32 v46, v46
    v_exp_f32 v47, v47
    s_waitcnt lgkmcnt(1)
    v_mfma_f32_32x32x16_bf16 v[20:35], v[84:87], v[68:71], v[20:35]
    v_exp_f32 v48, v48
    v_exp_f32 v49, v49
    v_exp_f32 v50, v50
    v_exp_f32 v51, v51
    s_nop 0
    v_cvt_pk_bf16_f32 v72, v44, v45
    v_cvt_pk_bf16_f32 v73, v46, v47
    v_cvt_pk_bf16_f32 v74, v48, v49
    v_cvt_pk_bf16_f32 v75, v50, v51
    ds_read_b128 v[92:95], v12 offset:9792
    ds_read_b128 v[96:99], v12 offset:10336
    v_exp_f32 v52, v52
    v_exp_f32 v53, v53
    v_exp_f32 v54, v54
    v_exp_f32 v55, v55
    v_mfma_f32_32x32x16_bf16 v[20:35], v[88:91], v[72:75], v[20:35]
    v_exp_f32 v56, v56
    v_exp_f32 v57, v57
    v_exp_f32 v58, v58
    v_exp_f32 v59, v59
    s_waitcnt lgkmcnt(2)
    v_cvt_pk_bf16_f32 v68, v52, v53
    v_cvt_pk_bf16_f32 v69, v54, v55
    v_cvt_pk_bf16_f32 v70, v56, v57
    v_cvt_pk_bf16_f32 v71, v58, v59
    v_mfma_f32_32x32x16_bf16 v[36:51], v[76:79], v[16:19], 0
    ds_read_b128 v[80:83], v3 offset:60416
    v_exp_f32 v60, v60
    v_exp_f32 v61, v61
    v_exp_f32 v62, v62
    v_exp_f32 v63, v63
    s_waitcnt lgkmcnt(1)
    v_mfma_f32_32x32x16_bf16 v[20:35], v[92:95], v[68:71], v[20:35]
    v_exp_f32 v64, v64
    v_exp_f32 v65, v65
    v_exp_f32 v66, v66
    v_exp_f32 v67, v67
    s_nop 0
    v_cvt_pk_bf16_f32 v72, v60, v61
    v_cvt_pk_bf16_f32 v73, v62, v63
    v_cvt_pk_bf16_f32 v74, v64, v65
    v_cvt_pk_bf16_f32 v75, v66, v67
    ds_read_b128 v[84:87], v12 offset:10880
    ds_read_b128 v[88:91], v12 offset:11424
    v_exp_f32 v36, v36
    v_exp_f32 v37, v37
    v_exp_f32 v38, v38
    v_exp_f32 v39, v39
    v_mfma_f32_32x32x16_bf16 v[20:35], v[96:99], v[72:75], v[20:35]
    v_exp_f32 v40, v40
    v_exp_f32 v41, v41
    v_exp_f32 v42, v42
    v_exp_f32 v43, v43
    s_waitcnt lgkmcnt(2)
    v_cvt_pk_bf16_f32 v68, v36, v37
    v_cvt_pk_bf16_f32 v69, v38, v39
    v_cvt_pk_bf16_f32 v70, v40, v41
    v_cvt_pk_bf16_f32 v71, v42, v43
    v_mfma_f32_32x32x16_bf16 v[52:67], v[80:83], v[16:19], 0
    ds_read_b128 v[76:79], v3 offset:61440
    v_exp_f32 v44, v44
    v_exp_f32 v45, v45
    v_exp_f32 v46, v46
    v_exp_f32 v47, v47
    s_waitcnt lgkmcnt(1)
    v_mfma_f32_32x32x16_bf16 v[20:35], v[84:87], v[68:71], v[20:35]
    v_exp_f32 v48, v48
    v_exp_f32 v49, v49
    v_exp_f32 v50, v50
    v_exp_f32 v51, v51
    s_nop 0
    v_cvt_pk_bf16_f32 v72, v44, v45
    v_cvt_pk_bf16_f32 v73, v46, v47
    v_cvt_pk_bf16_f32 v74, v48, v49
    v_cvt_pk_bf16_f32 v75, v50, v51
    ds_read_b128 v[92:95], v12 offset:11968
    ds_read_b128 v[96:99], v12 offset:12512
    v_exp_f32 v52, v52
    v_exp_f32 v53, v53
    v_exp_f32 v54, v54
    v_exp_f32 v55, v55
    v_mfma_f32_32x32x16_bf16 v[20:35], v[88:91], v[72:75], v[20:35]
    v_exp_f32 v56, v56
    v_exp_f32 v57, v57
    v_exp_f32 v58, v58
    v_exp_f32 v59, v59
    s_waitcnt lgkmcnt(2)
    v_cvt_pk_bf16_f32 v68, v52, v53
    v_cvt_pk_bf16_f32 v69, v54, v55
    v_cvt_pk_bf16_f32 v70, v56, v57
    v_cvt_pk_bf16_f32 v71, v58, v59
    v_mfma_f32_32x32x16_bf16 v[36:51], v[76:79], v[16:19], 0
    ds_read_b128 v[80:83], v3 offset:62464
    v_exp_f32 v60, v60
    v_exp_f32 v61, v61
    v_exp_f32 v62, v62
    v_exp_f32 v63, v63
    s_waitcnt lgkmcnt(1)
    v_mfma_f32_32x32x16_bf16 v[20:35], v[92:95], v[68:71], v[20:35]
    v_exp_f32 v64, v64
    v_exp_f32 v65, v65
    v_exp_f32 v66, v66
    v_exp_f32 v67, v67
    s_nop 0
    v_cvt_pk_bf16_f32 v72, v60, v61
    v_cvt_pk_bf16_f32 v73, v62, v63
    v_cvt_pk_bf16_f32 v74, v64, v65
    v_cvt_pk_bf16_f32 v75, v66, v67
    ds_read_b128 v[84:87], v12 offset:13056
    ds_read_b128 v[88:91], v12 offset:13600
    v_exp_f32 v36, v36
    v_exp_f32 v37, v37
    v_exp_f32 v38, v38
    v_exp_f32 v39, v39
    v_mfma_f32_32x32x16_bf16 v[20:35], v[96:99], v[72:75], v[20:35]
    v_exp_f32 v40, v40
    v_exp_f32 v41, v41
    v_exp_f32 v42, v42
    v_exp_f32 v43, v43
    s_waitcnt lgkmcnt(2)
    v_cvt_pk_bf16_f32 v68, v36, v37
    v_cvt_pk_bf16_f32 v69, v38, v39
    v_cvt_pk_bf16_f32 v70, v40, v41
    v_cvt_pk_bf16_f32 v71, v42, v43
    v_mfma_f32_32x32x16_bf16 v[52:67], v[80:83], v[16:19], 0
    ds_read_b128 v[76:79], v3 offset:63488
    v_exp_f32 v44, v44
    v_exp_f32 v45, v45
    v_exp_f32 v46, v46
    v_exp_f32 v47, v47
    s_waitcnt lgkmcnt(1)
    v_mfma_f32_32x32x16_bf16 v[20:35], v[84:87], v[68:71], v[20:35]
    v_exp_f32 v48, v48
    v_exp_f32 v49, v49
    v_exp_f32 v50, v50
    v_exp_f32 v51, v51
    s_nop 0
    v_cvt_pk_bf16_f32 v72, v44, v45
    v_cvt_pk_bf16_f32 v73, v46, v47
    v_cvt_pk_bf16_f32 v74, v48, v49
    v_cvt_pk_bf16_f32 v75, v50, v51
    ds_read_b128 v[92:95], v12 offset:14144
    ds_read_b128 v[96:99], v12 offset:14688
    v_exp_f32 v52, v52
    v_exp_f32 v53, v53
    v_exp_f32 v54, v54
    v_exp_f32 v55, v55
    v_mfma_f32_32x32x16_bf16 v[20:35], v[88:91], v[72:75], v[20:35]
    v_exp_f32 v56, v56
    v_exp_f32 v57, v57
    v_exp_f32 v58, v58
    v_exp_f32 v59, v59
    s_waitcnt lgkmcnt(2)
    v_cvt_pk_bf16_f32 v68, v52, v53
    v_cvt_pk_bf16_f32 v69, v54, v55
    v_cvt_pk_bf16_f32 v70, v56, v57
    v_cvt_pk_bf16_f32 v71, v58, v59
    v_mfma_f32_32x32x16_bf16 v[36:51], v[76:79], v[16:19], 0
    ds_read_b128 v[80:83], v3 offset:64512
    v_exp_f32 v60, v60
    v_exp_f32 v61, v61
    v_exp_f32 v62, v62
    v_exp_f32 v63, v63
    s_waitcnt lgkmcnt(1)
    v_mfma_f32_32x32x16_bf16 v[20:35], v[92:95], v[68:71], v[20:35]
    v_exp_f32 v64, v64
    v_exp_f32 v65, v65
    v_exp_f32 v66, v66
    v_exp_f32 v67, v67
    s_nop 0
    v_cvt_pk_bf16_f32 v72, v60, v61
    v_cvt_pk_bf16_f32 v73, v62, v63
    v_cvt_pk_bf16_f32 v74, v64, v65
    v_cvt_pk_bf16_f32 v75, v66, v67
    ds_read_b128 v[84:87], v12 offset:15232
    ds_read_b128 v[88:91], v12 offset:15776
    v_exp_f32 v36, v36
    v_exp_f32 v37, v37
    v_exp_f32 v38, v38
    v_exp_f32 v39, v39
    v_mfma_f32_32x32x16_bf16 v[20:35], v[96:99], v[72:75], v[20:35]
    v_exp_f32 v40, v40
    v_exp_f32 v41, v41
    v_exp_f32 v42, v42
    v_exp_f32 v43, v43
    s_waitcnt lgkmcnt(2)
    v_cvt_pk_bf16_f32 v68, v36, v37
    v_cvt_pk_bf16_f32 v69, v38, v39
    v_cvt_pk_bf16_f32 v70, v40, v41
    v_cvt_pk_bf16_f32 v71, v42, v43
    v_mfma_f32_32x32x16_bf16 v[52:67], v[80:83], v[16:19], 0
    v_exp_f32 v44, v44
    v_exp_f32 v45, v45
    v_exp_f32 v46, v46
    v_exp_f32 v47, v47
    s_waitcnt lgkmcnt(0)
    v_mfma_f32_32x32x16_bf16 v[20:35], v[84:87], v[68:71], v[20:35]
    v_exp_f32 v48, v48
    v_exp_f32 v49, v49
    v_exp_f32 v50, v50
    v_exp_f32 v51, v51
    s_nop 0
    v_cvt_pk_bf16_f32 v72, v44, v45
    v_cvt_pk_bf16_f32 v73, v46, v47
    v_cvt_pk_bf16_f32 v74, v48, v49
    v_cvt_pk_bf16_f32 v75, v50, v51
    ds_read_b128 v[92:95], v12 offset:16320
    ds_read_b128 v[96:99], v12 offset:16864
    v_exp_f32 v52, v52
    v_exp_f32 v53, v53
    v_exp_f32 v54, v54
    v_exp_f32 v55, v55
    v_mfma_f32_32x32x16_bf16 v[20:35], v[88:91], v[72:75], v[20:35]
    v_exp_f32 v56, v56
    v_exp_f32 v57, v57
    v_exp_f32 v58, v58
    v_exp_f32 v59, v59
    v_cvt_pk_bf16_f32 v68, v52, v53
    v_cvt_pk_bf16_f32 v69, v54, v55
    v_cvt_pk_bf16_f32 v70, v56, v57
    v_cvt_pk_bf16_f32 v71, v58, v59
    v_exp_f32 v60, v60
    v_exp_f32 v61, v61
    v_exp_f32 v62, v62
    v_exp_f32 v63, v63
    s_waitcnt lgkmcnt(0)
    v_mfma_f32_32x32x16_bf16 v[20:35], v[92:95], v[68:71], v[20:35]
    v_exp_f32 v64, v64
    v_exp_f32 v65, v65
    v_exp_f32 v66, v66
    v_exp_f32 v67, v67
    s_nop 0
    v_cvt_pk_bf16_f32 v72, v60, v61
    v_cvt_pk_bf16_f32 v73, v62, v63
    v_cvt_pk_bf16_f32 v74, v64, v65
    v_cvt_pk_bf16_f32 v75, v66, v67
    s_nop 1
    v_mfma_f32_32x32x16_bf16 v[20:35], v[96:99], v[72:75], v[20:35]
    s_setprio 0
    s_branch Lly_attdone_3
Lly_slow_2:
    s_add_u32 m0, s10, 16384
    s_add_u32 s14, s10, 45056
    buffer_load_dwordx4 v3, s[40:43], s14 offen lds
    s_add_u32 m0, s10, 82944
    s_add_u32 s14, s10, 111616
    buffer_load_dwordx4 v3, s[40:43], s14 offen lds
    s_add_u32 m0, s10, 91136
    s_add_u32 s14, s10, 119808
    buffer_load_dwordx4 v3, s[40:43], s14 offen lds
    s_add_u32 m0, s10, 24576
    s_add_u32 s14, s10, 53248
    buffer_load_dwordx4 v3, s[40:43], s14 offen lds
    s_mov_b32 m0, 99328
    s_mov_b32 s14, 128000
    buffer_load_dwordx4 v3, s[40:43], s14 offen lds
    s_add_u32 m0, s10, 32768
    s_add_u32 s14, s10, 61440
    buffer_load_dwordx4 v3, s[40:43], s14 offen lds
    s_add_u32 m0, s10, 100352
    s_add_u32 s14, s10, 129024
    buffer_load_dwordx4 v3, s[40:43], s14 offen lds
    s_add_u32 m0, s10, 108544
    s_add_u32 s14, s10, 137216
    buffer_load_dwordx4 v3, s[40:43], s14 offen lds
    s_add_u32 m0, s10, 40960
    s_add_u32 s14, s10, 69632
    buffer_load_dwordx4 v3, s[40:43], s14 offen lds
    s_mov_b32 m0, 116736
    s_mov_b32 s14, 145408
    buffer_load_dwordx4 v3, s[40:43], s14 offen lds
    s_add_u32 m0, s10, 49152
    s_add_u32 s14, s10, 77824
    buffer_load_dwordx4 v3, s[40:43], s14 offen lds
    s_add_u32 m0, s10, 117760
    s_add_u32 s14, s10, 146432
    buffer_load_dwordx4 v3, s[40:43], s14 offen lds
    s_add_u32 m0, s10, 125952
    s_add_u32 s14, s10, 154624
    buffer_load_dwordx4 v3, s[40:43], s14 offen lds
    s_add_u32 m0, s10, 57344
    s_add_u32 s14, s10, 86016
    buffer_load_dwordx4 v3, s[40:43], s14 offen lds
    s_mov_b32 m0, 134144
    s_mov_b32 s14, 162816
    buffer_load_dwordx4 v3, s[40:43], s14 offen lds
    buffer_load_dwordx4 v[112:115], v3, s[40:43], s44 offen offset:0
    buffer_load_dwordx4 v[116:119], v3, s[40:43], s44 offen offset:1024
    buffer_load_dwordx4 v[120:123], v3, s[40:43], s44 offen offset:2048
    buffer_load_dwordx4 v[124:127], v3, s[40:43], s44 offen offset:3072
    s_add_u32 s60, s44, 32768
    buffer_load_dwordx4 v[128:131], v3, s[40:43], s60 offen offset:0
    s_add_u32 s60, s44, 32768
    buffer_load_dwordx4 v[132:135], v3, s[40:43], s60 offen offset:1024
    s_add_u32 s60, s44, 32768
    buffer_load_dwordx4 v[136:139], v3, s[40:43], s60 offen offset:2048
    s_add_u32 s60, s44, 32768
    buffer_load_dwordx4 v[140:143], v3, s[40:43], s60 offen offset:3072
    s_add_u32 s60, s45, 0
    buffer_load_dwordx4 v[144:147], v3, s[40:43], s60 offen offset:0
    s_add_u32 s60, s45, 0
    buffer_load_dwordx4 v[148:151], v3, s[40:43], s60 offen offset:1024
    s_add_u32 s60, s45, 0
    buffer_load_dwordx4 v[152:155], v3, s[40:43], s60 offen offset:2048
    s_add_u32 s60, s45, 0
    buffer_load_dwordx4 v[156:159], v3, s[40:43], s60 offen offset:3072
    s_add_u32 s60, s45, 4096
    buffer_load_dwordx4 v[160:163], v3, s[40:43], s60 offen offset:0
    s_add_u32 s60, s45, 4096
    buffer_load_dwordx4 v[164:167], v3, s[40:43], s60 offen offset:1024
    s_add_u32 s60, s45, 4096
    buffer_load_dwordx4 v[168:171], v3, s[40:43], s60 offen offset:2048
    s_add_u32 s60, s45, 4096
    buffer_load_dwordx4 v[172:175], v3, s[40:43], s60 offen offset:3072
    s_add_u32 s60, s45, 8192
    buffer_load_dwordx4 v[176:179], v3, s[40:43], s60 offen offset:0
    s_add_u32 s60, s45, 8192
    buffer_load_dwordx4 v[180:183], v3, s[40:43], s60 offen offset:1024
    s_add_u32 s60, s45, 8192
    buffer_load_dwordx4 v[184:187], v3, s[40:43], s60 offen offset:2048
    s_add_u32 s60, s45, 8192
    buffer_load_dwordx4 v[188:191], v3, s[40:43], s60 offen offset:3072
    s_add_u32 s60, s45, 12288
    buffer_load_dwordx4 v[192:195], v3, s[40:43], s60 offen offset:0
    s_add_u32 s60, s45, 12288
    buffer_load_dwordx4 v[196:199], v3, s[40:43], s60 offen offset:1024
    s_add_u32 s60, s45, 12288
    buffer_load_dwordx4 v[200:203], v3, s[40:43], s60 offen offset:2048
    s_add_u32 s60, s45, 12288
    buffer_load_dwordx4 v[204:207], v3, s[40:43], s60 offen offset:3072
    s_add_u32 s60, s45, 16384
    buffer_load_dwordx4 v[208:211], v3, s[40:43], s60 offen offset:0
    s_add_u32 s60, s45, 16384
    buffer_load_dwordx4 v[212:215], v3, s[40:43], s60 offen offset:1024
    s_add_u32 s60, s45, 16384
    buffer_load_dwordx4 v[216:219], v3, s[40:43], s60 offen offset:2048
    s_add_u32 s60, s45, 16384
    buffer_load_dwordx4 v[220:223], v3, s[40:43], s60 offen offset:3072
    s_add_u32 s60, s45, 20480
    buffer_load_dwordx4 v[224:227], v3, s[40:43], s60 offen offset:0
    s_add_u32 s60, s45, 20480
    buffer_load_dwordx4 v[228:231], v3, s[40:43], s60 offen offset:1024
    s_add_u32 s60, s45, 20480
    buffer_load_dwordx4 v[232:235], v3, s[40:43], s60 offen offset:2048
    s_add_u32 s60, s45, 20480
    buffer_load_dwordx4 v[236:239], v3, s[40:43], s60 offen offset:3072
    s_add_u32 s60, s45, 24576
    buffer_load_dwordx4 v[240:243], v3, s[40:43], s60 offen offset:0
    s_add_u32 s60, s45, 24576
    buffer_load_dwordx4 v[244:247], v3, s[40:43], s60 offen offset:1024
    s_add_u32 s60, s45, 24576
    buffer_load_dwordx4 v[248:251], v3, s[40:43], s60 offen offset:2048
    s_add_u32 s60, s45, 24576
    buffer_load_dwordx4 v[252:255], v3, s[40:43], s60 offen offset:3072
    s_add_u32 s60, s45, 28672
    buffer_load_dword v101, v100, s[40:43], s60 offen
    s_add_u32 s60, s46, 0
    buffer_load_dword v101, v100, s[40:43], s60 offen
    s_add_u32 s60, s46, 8192
    buffer_load_dword v101, v100, s[40:43], s60 offen
    s_add_u32 s60, s46, 114688
    buffer_load_dword v101, v100, s[40:43], s60 offen
    s_add_u32 s60, s46, 122880
    buffer_load_dword v101, v100, s[40:43], s60 offen
    s_add_u32 s60, s47, 0
    buffer_load_dword v101, v100, s[40:43], s60 offen
    s_add_u32 s60, s47, 32768
    buffer_load_dword v101, v100, s[40:43], s60 offen
    buffer_load_dword v102, v103, s[40:43], s54 offen sc1
    s_waitcnt vmcnt(0)
    s_barrier
    s_barrier
    v_mov_b32 v8, v3
    v_mov_b32 v13, 0xff800000
    s_mov_b32 s21, 0
Lly_mx_5:
    ds_read_b128 v[76:79], v8
    s_waitcnt lgkmcnt(0)
    v_mfma_f32_32x32x16_bf16 v[36:51], v[76:79], v[16:19], 0
    s_nop 15
    v_max3_f32 v13, v36, v37, v13
    v_max3_f32 v13, v38, v39, v13
    v_max3_f32 v13, v40, v41, v13
    v_max3_f32 v13, v42, v43, v13
    v_max3_f32 v13, v44, v45, v13
    v_max3_f32 v13, v46, v47, v13
    v_max3_f32 v13, v48, v49, v13
    v_max3_f32 v13, v50, v51, v13
    v_add_u32 v8, 1024, v8
    s_add_u32 s21, s21, 1
    s_cmp_lt_u32 s21, 64
    s_cbranch_scc1 Lly_mx_5
    v_xor_b32 v14, 32, v1
    v_lshlrev_b32 v14, 2, v14
    ds_bpermute_b32 v15, v14, v13
    s_waitcnt lgkmcnt(0)
    v_max_f32 v13, v13, v15
    v_sub_f32 v13, 0, v13
    v_mov_b32 v52, v13
    v_mov_b32 v53, v13
    v_mov_b32 v54, v13
    v_mov_b32 v55, v13
    v_mov_b32 v56, v13
    v_mov_b32 v57, v13
    v_mov_b32 v58, v13
    v_mov_b32 v59, v13
    v_mov_b32 v60, v13
    v_mov_b32 v61, v13
    v_mov_b32 v62, v13
    v_mov_b32 v63, v13
    v_mov_b32 v64, v13
    v_mov_b32 v65, v13
    v_mov_b32 v66, v13
    v_mov_b32 v67, v13
    v_mov_b32 v8, v3
    s_mov_b32 s21, 0
Lly_sl_6:
    ds_read_b128 v[76:79], v8
    ds_read_b128 v[84:87], v12
    ds_read_b128 v[88:91], v12 offset:544
    s_waitcnt lgkmcnt(0)
    v_mfma_f32_32x32x16_bf16 v[36:51], v[76:79], v[16:19], v[52:67]
    s_nop 15
    v_exp_f32 v36, v36
    v_exp_f32 v37, v37
    v_exp_f32 v38, v38
    v_exp_f32 v39, v39
    v_exp_f32 v40, v40
    v_exp_f32 v41, v41
    v_exp_f32 v42, v42
    v_exp_f32 v43, v43
    v_exp_f32 v44, v44
    v_exp_f32 v45, v45
    v_exp_f32 v46, v46
    v_exp_f32 v47, v47
    v_exp_f32 v48, v48
    v_exp_f32 v49, v49
    v_exp_f32 v50, v50
    v_exp_f32 v51, v51
    s_nop 0
    v_cvt_pk_bf16_f32 v68, v36, v37
    v_cvt_pk_bf16_f32 v69, v38, v39
    v_cvt_pk_bf16_f32 v70, v40, v41
    v_cvt_pk_bf16_f32 v71, v42, v43
    v_cvt_pk_bf16_f32 v72, v44, v45
    v_cvt_pk_bf16_f32 v73, v46, v47
    v_cvt_pk_bf16_f32 v74, v48, v49
    v_cvt_pk_bf16_f32 v75, v50, v51
    s_nop 1
    v_mfma_f32_32x32x16_bf16 v[20:35], v[84:87], v[68:71], v[20:35]
    v_mfma_f32_32x32x16_bf16 v[20:35], v[88:91], v[72:75], v[20:35]
    v_add_u32 v8, 1024, v8
    v_add_u32 v12, 1088, v12
    s_add_u32 s21, s21, 1
    s_cmp_lt_u32 s21, 64
    s_cbranch_scc1 Lly_sl_6
Lly_attdone_3:
    s_nop 15
    v_rcp_f32 v13, v28
    s_nop 0
    v_mul_f32 v20, v13, v20
    v_mul_f32 v21, v13, v21
    v_mul_f32 v22, v13, v22
    v_mul_f32 v23, v13, v23
    v_mul_f32 v24, v13, v24
    v_mul_f32 v25, v13, v25
    v_mul_f32 v26, v13, v26
    v_mul_f32 v27, v13, v27
    v_cvt_pk_bf16_f32 v68, v20, v21
    v_cvt_pk_bf16_f32 v69, v22, v23
    v_cvt_pk_bf16_f32 v70, v24, v25
    v_cvt_pk_bf16_f32 v71, v26, v27
    s_mov_b32 s61, 0
    s_branch Lly_pc_9
Lly_pp_7:
    buffer_load_dword v102, v103, s[40:43], s54 offen sc1
Lly_pc_9:
    s_waitcnt vmcnt(0)
    v_readfirstlane_b32 s62, v102
    s_and_b32 s63, s62, 0x0f0f0f0f
    s_lshr_b32 s60, s62, 4
    s_and_b32 s60, s60, 0x0f0f0f0f
    s_add_u32 s63, s63, s60
    s_mul_i32 s63, s63, 0x01010101
    s_lshr_b32 s63, s63, 24
    s_cmp_ge_u32 s63, 8
    s_cbranch_scc1 Lly_pd_8
    s_add_u32 s61, s61, 1
    s_cmp_ge_u32 s61, 0x400000
    s_cbranch_scc1 Lly_pd_8
    s_sleep 1
    s_branch Lly_pp_7
Lly_pd_8:
    s_lshl_b32 s60, 8, s53
    s_cmp_eq_u32 s62, s60
    s_cselect_b32 s52, 1, 0
    buffer_store_dwordx4 v[68:71], v3, s[40:43], s8 offen sc1
    s_waitcnt vmcnt(0)
    s_barrier
    s_cmp_lg_u32 s3, 7
    s_cbranch_scc1 Lly_sig_10
    s_lshl_b32 s60, s5, 7
    s_lshl_b32 s61, s6, 2
    s_add_u32 s60, s60, s61
    s_add_u32 s60, s60, 0
    v_mov_b32 v4, 1
    v_mov_b32 v5, 0
    s_mov_b64 exec, 1
    s_cmp_eq_u32 s52, 1
    s_cbranch_scc1 Lly_hs_11
    buffer_store_dword v4, v5, s[40:43], s60 offen sc1
    s_branch Lly_he_12
Lly_hs_11:
    buffer_store_dword v4, v5, s[40:43], s60 offen
Lly_he_12:
    s_mov_b64 exec, -1
Lly_sig_10:
    s_lshl_b32 s60, s5, 7
    s_lshl_b32 s61, s3, 2
    s_add_u32 s60, s60, s61
    s_add_u32 s60, s60, 0
    v_mov_b32 v5, 0
    s_mov_b32 s61, 0
    s_mov_b64 exec, 1
Lly_wp_13:
    buffer_load_dword v4, v5, s[40:43], s60 offen sc1
    s_waitcnt vmcnt(0)
    v_readfirstlane_b32 s62, v4
    s_cmp_eq_u32 s62, 1
    s_cbranch_scc1 Lly_wd_14
    s_add_u32 s61, s61, 1
    s_cmp_ge_u32 s61, 0x400000
    s_cbranch_scc1 Lly_wd_14
    s_sleep 1
    s_branch Lly_wp_13
Lly_wd_14:
    s_mov_b64 exec, -1
    s_lshl_b32 s8, s5, 16
    s_lshl_b32 s9, s3, 12
    s_add_u32 s8, s8, s9
    s_add_u32 s8, s8, 6455296
    s_add_u32 s9, s8, 32768
    buffer_load_dwordx4 v[80:83], v3, s[40:43], s8 offen offset:0 sc1
    buffer_load_dwordx4 v[84:87], v3, s[40:43], s9 offen offset:0 sc1
    buffer_load_dwordx4 v[88:91], v3, s[40:43], s8 offen offset:1024 sc1
    buffer_load_dwordx4 v[92:95], v3, s[40:43], s9 offen offset:1024 sc1
    buffer_load_dwordx4 v[96:99], v3, s[40:43], s8 offen offset:2048 sc1
    buffer_load_dwordx4 v[100:103], v3, s[40:43], s9 offen offset:2048 sc1
    buffer_load_dwordx4 v[104:107], v3, s[40:43], s8 offen offset:3072 sc1
    buffer_load_dwordx4 v[108:111], v3, s[40:43], s9 offen offset:3072 sc1
    s_lshr_b32 s60, s3, 1
    s_and_b32 s56, s60, 1
    s_lshl_b32 s61, s5, 1
    s_add_u32 s56, s56, s61
    s_lshr_b32 s57, s3, 2
    s_lshl_b32 s61, s6, 1
    s_add_u32 s57, s57, s61
    s_lshl_b32 s57, s57, 1
    s_and_b32 s61, s3, 1
    s_add_u32 s57, s57, s61
    s_lshl_b32 s58, s56, 5
    s_add_u32 s58, s58, s57
    s_lshl_b32 s58, s58, 10
    s_add_u32 s58, s58, 0
    s_mov_b32 s64, s16
    s_and_b32 s65, s17, 0xffff
    s_mov_b32 s66, 2097152
    s_mov_b32 s67, 0x00020000
    s_add_u32 s59, s58, 2260992
    s_cmp_lg_u32 s38, 0
    s_cbranch_scc1 Lly_rr_15
    v_and_b32 v0, 31, v1
    v_lshlrev_b32 v0, 10, v0
    v_lshrrev_b32 v2, 5, v1
    v_lshl_add_u32 v0, v2, 3, v0
    s_lshl_b32 s60, s56, 15
    s_lshl_b32 s61, s57, 5
    s_add_u32 s60, s60, s61
    buffer_load_dwordx2 v[12:13], v0, s[64:67], s60 offen
    buffer_load_dwordx2 v[14:15], v0, s[64:67], s60 offen offset:16
    s_branch Lly_rs_16
Lly_rr_15:
    s_add_u32 s58, s58, 163840
    buffer_load_dwordx2 v[12:13], v3, s[40:43], s58 offen
    buffer_load_dwordx2 v[14:15], v3, s[40:43], s58 offen offset:8
Lly_rs_16:
    s_waitcnt vmcnt(8)
    v_mfma_f32_32x32x16_bf16 v[16:31], v[112:115], v[80:83], 0
    v_mfma_f32_32x32x16_bf16 v[32:47], v[112:115], v[84:87], 0
    v_mfma_f32_32x32x16_bf16 v[48:63], v[128:131], v[80:83], 0
    v_mfma_f32_32x32x16_bf16 v[64:79], v[128:131], v[84:87], 0
    s_waitcnt vmcnt(6)
    v_mfma_f32_32x32x16_bf16 v[16:31], v[116:119], v[88:91], v[16:31]
    v_mfma_f32_32x32x16_bf16 v[32:47], v[116:119], v[92:95], v[32:47]
    v_mfma_f32_32x32x16_bf16 v[48:63], v[132:135], v[88:91], v[48:63]
    v_mfma_f32_32x32x16_bf16 v[64:79], v[132:135], v[92:95], v[64:79]
    s_waitcnt vmcnt(4)
    v_mfma_f32_32x32x16_bf16 v[16:31], v[120:123], v[96:99], v[16:31]
    v_mfma_f32_32x32x16_bf16 v[32:47], v[120:123], v[100:103], v[32:47]
    v_mfma_f32_32x32x16_bf16 v[48:63], v[136:139], v[96:99], v[48:63]
    v_mfma_f32_32x32x16_bf16 v[64:79], v[136:139], v[100:103], v[64:79]
    s_waitcnt vmcnt(2)
    v_mfma_f32_32x32x16_bf16 v[16:31], v[124:127], v[104:107], v[16:31]
    v_mfma_f32_32x32x16_bf16 v[32:47], v[124:127], v[108:111], v[32:47]
    v_mfma_f32_32x32x16_bf16 v[48:63], v[140:143], v[104:107], v[48:63]
    v_mfma_f32_32x32x16_bf16 v[64:79], v[140:143], v[108:111], v[64:79]
    s_nop 13
    s_lshl_b32 s60, s3, 14
    v_add_u32 v0, s60, v3
    s_cmp_eq_u32 s3, 0
    s_cbranch_scc1 Lly_rw_17
    ds_write_b128 v0, v[16:19] offset:0
    ds_write_b128 v0, v[20:23] offset:1024
    s_branch Lly_rx_18
Lly_rw_17:
    v_mov_b32 v4, v16
    v_mov_b32 v5, v17
    v_mov_b32 v6, v18
    v_mov_b32 v7, v19
    v_mov_b32 v8, v20
    v_mov_b32 v9, v21
    v_mov_b32 v10, v22
    v_mov_b32 v11, v23
Lly_rx_18:
    s_add_u32 s60, s45, 28672
    buffer_load_dwordx4 v[80:83], v3, s[40:43], s60 offen offset:0
    s_cmp_eq_u32 s3, 1
    s_cbranch_scc1 Lly_rw_19
    ds_write_b128 v0, v[24:27] offset:2048
    ds_write_b128 v0, v[28:31] offset:3072
    s_branch Lly_rx_20
Lly_rw_19:
    v_mov_b32 v4, v24
    v_mov_b32 v5, v25
    v_mov_b32 v6, v26
    v_mov_b32 v7, v27
    v_mov_b32 v8, v28
    v_mov_b32 v9, v29
    v_mov_b32 v10, v30
    v_mov_b32 v11, v31
Lly_rx_20:
    s_add_u32 s60, s45, 28672
    buffer_load_dwordx4 v[84:87], v3, s[40:43], s60 offen offset:1024
    s_cmp_eq_u32 s3, 2
    s_cbranch_scc1 Lly_rw_21
    ds_write_b128 v0, v[32:35] offset:4096
    ds_write_b128 v0, v[36:39] offset:5120
    s_branch Lly_rx_22
Lly_rw_21:
    v_mov_b32 v4, v32
    v_mov_b32 v5, v33
    v_mov_b32 v6, v34
    v_mov_b32 v7, v35
    v_mov_b32 v8, v36
    v_mov_b32 v9, v37
    v_mov_b32 v10, v38
    v_mov_b32 v11, v39
Lly_rx_22:
    s_add_u32 s60, s45, 28672
    buffer_load_dwordx4 v[88:91], v3, s[40:43], s60 offen offset:2048
    s_cmp_eq_u32 s3, 3
    s_cbranch_scc1 Lly_rw_23
    ds_write_b128 v0, v[40:43] offset:6144
    ds_write_b128 v0, v[44:47] offset:7168
    s_branch Lly_rx_24
Lly_rw_23:
    v_mov_b32 v4, v40
    v_mov_b32 v5, v41
    v_mov_b32 v6, v42
    v_mov_b32 v7, v43
    v_mov_b32 v8, v44
    v_mov_b32 v9, v45
    v_mov_b32 v10, v46
    v_mov_b32 v11, v47
Lly_rx_24:
    s_add_u32 s60, s45, 28672
    buffer_load_dwordx4 v[92:95], v3, s[40:43], s60 offen offset:3072
    s_cmp_eq_u32 s3, 4
    s_cbranch_scc1 Lly_rw_25
    ds_write_b128 v0, v[48:51] offset:8192
    ds_write_b128 v0, v[52:55] offset:9216
    s_branch Lly_rx_26
Lly_rw_25:
    v_mov_b32 v4, v48
    v_mov_b32 v5, v49
    v_mov_b32 v6, v50
    v_mov_b32 v7, v51
    v_mov_b32 v8, v52
    v_mov_b32 v9, v53
    v_mov_b32 v10, v54
    v_mov_b32 v11, v55
Lly_rx_26:
    s_add_u32 s60, s46, 0
    buffer_load_dwordx4 v[96:99], v3, s[40:43], s60 offen offset:0
    s_cmp_eq_u32 s3, 5
    s_cbranch_scc1 Lly_rw_27
    ds_write_b128 v0, v[56:59] offset:10240
    ds_write_b128 v0, v[60:63] offset:11264
    s_branch Lly_rx_28
Lly_rw_27:
    v_mov_b32 v4, v56
    v_mov_b32 v5, v57
    v_mov_b32 v6, v58
    v_mov_b32 v7, v59
    v_mov_b32 v8, v60
    v_mov_b32 v9, v61
    v_mov_b32 v10, v62
    v_mov_b32 v11, v63
Lly_rx_28:
    s_add_u32 s60, s46, 114688
    buffer_load_dwordx4 v[100:103], v3, s[40:43], s60 offen offset:0
    s_cmp_eq_u32 s3, 6
    s_cbranch_scc1 Lly_rw_29
    ds_write_b128 v0, v[64:67] offset:12288
    ds_write_b128 v0, v[68:71] offset:13312
    s_branch Lly_rx_30
Lly_rw_29:
    v_mov_b32 v4, v64
    v_mov_b32 v5, v65
    v_mov_b32 v6, v66
    v_mov_b32 v7, v67
    v_mov_b32 v8, v68
    v_mov_b32 v9, v69
    v_mov_b32 v10, v70
    v_mov_b32 v11, v71
Lly_rx_30:
    s_add_u32 s60, s46, 0
    buffer_load_dwordx4 v[104:107], v3, s[40:43], s60 offen offset:1024
    s_cmp_eq_u32 s3, 7
    s_cbranch_scc1 Lly_rw_31
    ds_write_b128 v0, v[72:75] offset:14336
    ds_write_b128 v0, v[76:79] offset:15360
    s_branch Lly_rx_32
Lly_rw_31:
    v_mov_b32 v4, v72
    v_mov_b32 v5, v73
    v_mov_b32 v6, v74
    v_mov_b32 v7, v75
    v_mov_b32 v8, v76
    v_mov_b32 v9, v77
    v_mov_b32 v10, v78
    v_mov_b32 v11, v79
Lly_rx_32:
    s_add_u32 s60, s46, 114688
    buffer_load_dwordx4 v[108:111], v3, s[40:43], s60 offen offset:1024
    s_waitcnt lgkmcnt(0)
    s_barrier
    s_lshl_b32 s60, s3, 11
    v_add_u32 v0, s60, v3
    s_add_u32 s61, s3, 1
    s_and_b32 s61, s61, 7
    s_lshl_b32 s61, s61, 14
    v_add_u32 v2, s61, v0
    ds_read_b128 v[16:19], v2 offset:0
    ds_read_b128 v[20:23], v2 offset:1024
    s_add_u32 s61, s3, 2
    s_and_b32 s61, s61, 7
    s_lshl_b32 s61, s61, 14
    v_add_u32 v2, s61, v0
    ds_read_b128 v[24:27], v2 offset:0
    ds_read_b128 v[28:31], v2 offset:1024
    s_add_u32 s61, s3, 3
    s_and_b32 s61, s61, 7
    s_lshl_b32 s61, s61, 14
    v_add_u32 v2, s61, v0
    ds_read_b128 v[32:35], v2 offset:0
    ds_read_b128 v[36:39], v2 offset:1024
    s_add_u32 s61, s3, 4
    s_and_b32 s61, s61, 7
    s_lshl_b32 s61, s61, 14
    v_add_u32 v2, s61, v0
    ds_read_b128 v[40:43], v2 offset:0
    ds_read_b128 v[44:47], v2 offset:1024
    s_add_u32 s61, s3, 5
    s_and_b32 s61, s61, 7
    s_lshl_b32 s61, s61, 14
    v_add_u32 v2, s61, v0
    ds_read_b128 v[48:51], v2 offset:0
    ds_read_b128 v[52:55], v2 offset:1024
    s_add_u32 s61, s3, 6
    s_and_b32 s61, s61, 7
    s_lshl_b32 s61, s61, 14
    v_add_u32 v2, s61, v0
    ds_read_b128 v[56:59], v2 offset:0
    ds_read_b128 v[60:63], v2 offset:1024
    s_add_u32 s61, s3, 7
    s_and_b32 s61, s61, 7
    s_lshl_b32 s61, s61, 14
    v_add_u32 v2, s61, v0
    ds_read_b128 v[64:67], v2 offset:0
    ds_read_b128 v[68:71], v2 offset:1024
    s_add_u32 s60, s46, 0
    buffer_load_dwordx4 v[112:115], v3, s[40:43], s60 offen offset:2048
    s_add_u32 s60, s46, 114688
    buffer_load_dwordx4 v[116:119], v3, s[40:43], s60 offen offset:2048
    s_waitcnt lgkmcnt(12)
    v_add_f32 v4, v4, v16
    v_add_f32 v5, v5, v17
    v_add_f32 v6, v6, v18
    v_add_f32 v7, v7, v19
    v_add_f32 v8, v8, v20
    v_add_f32 v9, v9, v21
    v_add_f32 v10, v10, v22
    v_add_f32 v11, v11, v23
    s_waitcnt lgkmcnt(10)
    v_add_f32 v4, v4, v24
    v_add_f32 v5, v5, v25
    v_add_f32 v6, v6, v26
    v_add_f32 v7, v7, v27
    v_add_f32 v8, v8, v28
    v_add_f32 v9, v9, v29
    v_add_f32 v10, v10, v30
    v_add_f32 v11, v11, v31
    s_waitcnt lgkmcnt(8)
    v_add_f32 v4, v4, v32
    v_add_f32 v5, v5, v33
    v_add_f32 v6, v6, v34
    v_add_f32 v7, v7, v35
    v_add_f32 v8, v8, v36
    v_add_f32 v9, v9, v37
    v_add_f32 v10, v10, v38
    v_add_f32 v11, v11, v39
    s_waitcnt lgkmcnt(6)
    v_add_f32 v4, v4, v40
    v_add_f32 v5, v5, v41
    v_add_f32 v6, v6, v42
    v_add_f32 v7, v7, v43
    v_add_f32 v8, v8, v44
    v_add_f32 v9, v9, v45
    v_add_f32 v10, v10, v46
    v_add_f32 v11, v11, v47
    s_waitcnt lgkmcnt(4)
    v_add_f32 v4, v4, v48
    v_add_f32 v5, v5, v49
    v_add_f32 v6, v6, v50
    v_add_f32 v7, v7, v51
    v_add_f32 v8, v8, v52
    v_add_f32 v9, v9, v53
    v_add_f32 v10, v10, v54
    v_add_f32 v11, v11, v55
    s_waitcnt lgkmcnt(2)
    v_add_f32 v4, v4, v56
    v_add_f32 v5, v5, v57
    v_add_f32 v6, v6, v58
    v_add_f32 v7, v7, v59
    v_add_f32 v8, v8, v60
    v_add_f32 v9, v9, v61
    v_add_f32 v10, v10, v62
    v_add_f32 v11, v11, v63
    s_waitcnt lgkmcnt(0)
    v_add_f32 v4, v4, v64
    v_add_f32 v5, v5, v65
    v_add_f32 v6, v6, v66
    v_add_f32 v7, v7, v67
    v_add_f32 v8, v8, v68
    v_add_f32 v9, v9, v69
    v_add_f32 v10, v10, v70
    v_add_f32 v11, v11, v71
    s_waitcnt vmcnt(10)
    v_cvt_pk_bf16_f32 v16, v4, v5
    v_cvt_pk_bf16_f32 v17, v6, v7
    v_cvt_pk_bf16_f32 v18, v8, v9
    v_cvt_pk_bf16_f32 v19, v10, v11
    v_lshlrev_b32 v4, 16, v16
    v_and_b32 v5, 0xffff0000, v16
    v_lshlrev_b32 v24, 16, v12
    v_and_b32 v25, 0xffff0000, v12
    v_add_f32 v4, v4, v24
    v_add_f32 v5, v5, v25
    v_lshlrev_b32 v6, 16, v17
    v_and_b32 v7, 0xffff0000, v17
    v_lshlrev_b32 v24, 16, v13
    v_and_b32 v25, 0xffff0000, v13
    v_add_f32 v6, v6, v24
    v_add_f32 v7, v7, v25
    v_lshlrev_b32 v8, 16, v18
    v_and_b32 v9, 0xffff0000, v18
    v_lshlrev_b32 v24, 16, v14
    v_and_b32 v25, 0xffff0000, v14
    v_add_f32 v8, v8, v24
    v_add_f32 v9, v9, v25
    v_lshlrev_b32 v10, 16, v19
    v_and_b32 v11, 0xffff0000, v19
    v_lshlrev_b32 v24, 16, v15
    v_and_b32 v25, 0xffff0000, v15
    v_add_f32 v10, v10, v24
    v_add_f32 v11, v11, v25
    v_cvt_pk_bf16_f32 v16, v4, v5
    v_cvt_pk_bf16_f32 v17, v6, v7
    v_cvt_pk_bf16_f32 v18, v8, v9
    v_cvt_pk_bf16_f32 v19, v10, v11
    v_lshlrev_b32 v4, 16, v16
    v_and_b32 v5, 0xffff0000, v16
    v_lshlrev_b32 v6, 16, v17
    v_and_b32 v7, 0xffff0000, v17
    v_lshlrev_b32 v8, 16, v18
    v_and_b32 v9, 0xffff0000, v18
    v_lshlrev_b32 v10, 16, v19
    v_and_b32 v11, 0xffff0000, v19
    v_add_f32 v24, v4, v5
    v_mul_f32 v25, v4, v4
    v_fmac_f32 v25, v5, v5
    v_add_f32 v24, v24, v6
    v_fmac_f32 v25, v6, v6
    v_add_f32 v24, v24, v7
    v_fmac_f32 v25, v7, v7
    v_add_f32 v24, v24, v8
    v_fmac_f32 v25, v8, v8
    v_add_f32 v24, v24, v9
    v_fmac_f32 v25, v9, v9
    v_add_f32 v24, v24, v10
    v_fmac_f32 v25, v10, v10
    v_add_f32 v24, v24, v11
    v_fmac_f32 v25, v11, v11
    v_mov_b32 v26, v24
    v_mov_b32 v27, v25
    v_and_b32 v0, 31, v1
    v_lshlrev_b32 v0, 3, v0
    v_permlane32_swap_b32 v24, v26
    v_permlane32_swap_b32 v25, v27
    s_lshl_b32 s60, s56, 5
    s_add_u32 s60, s60, s57
    s_lshl_b32 s60, s60, 8
    s_add_u32 s60, s60, 15892480
    v_add_f32 v24, v24, v26
    v_add_f32 v25, v25, v27
    s_cmp_eq_u32 s52, 1
    s_cbranch_scc1 Lly_hs_35
    buffer_store_dwordx4 v[16:19], v3, s[40:43], s59 offen sc1
    buffer_store_dwordx2 v[24:25], v0, s[40:43], s60 offen sc1
    s_branch Lly_he_36
Lly_hs_35:
    buffer_store_dwordx4 v[16:19], v3, s[40:43], s59 offen
    buffer_store_dwordx2 v[24:25], v0, s[40:43], s60 offen
Lly_he_36:
    s_waitcnt vmcnt(0)
    s_barrier
    s_cmp_lg_u32 s3, 7
    s_cbranch_scc1 Lly_sig_37
    s_lshl_b32 s60, s5, 7
    s_lshl_b32 s61, s6, 2
    s_add_u32 s60, s60, s61
    s_add_u32 s60, s60, 4096
    v_mov_b32 v4, 1
    v_mov_b32 v5, 0
    s_mov_b64 exec, 1
    s_cmp_eq_u32 s52, 1
    s_cbranch_scc1 Lly_hs_38
    buffer_store_dword v4, v5, s[40:43], s60 offen sc1
    s_branch Lly_he_39
Lly_hs_38:
    buffer_store_dword v4, v5, s[40:43], s60 offen
Lly_he_39:
    s_mov_b64 exec, -1
Lly_sig_37:
    s_lshl_b32 s60, s5, 7
    s_lshl_b32 s61, s3, 2
    s_add_u32 s60, s60, s61
    s_add_u32 s60, s60, 4096
    v_mov_b32 v5, 0
    s_mov_b32 s61, 0
    s_mov_b64 exec, 1
Lly_wp_40:
    buffer_load_dword v4, v5, s[40:43], s60 offen sc1
    s_waitcnt vmcnt(0)
    v_readfirstlane_b32 s62, v4
    s_cmp_eq_u32 s62, 1
    s_cbranch_scc1 Lly_wd_41
    s_add_u32 s61, s61, 1
    s_cmp_ge_u32 s61, 0x400000
    s_cbranch_scc1 Lly_wd_41
    s_sleep 1
    s_branch Lly_wp_40
Lly_wd_41:
    s_mov_b64 exec, -1
    s_lshl_b32 s8, s5, 16
    s_lshl_b32 s9, s3, 12
    s_add_u32 s8, s8, s9
    s_add_u32 s8, s8, 2260992
    s_mov_b32 m0, s9
    s_add_u32 s10, s8, 32768
    buffer_load_dwordx4 v3, s[40:43], s8 offen offset:0 sc1 lds
    buffer_load_dwordx4 v3, s[40:43], s8 offen offset:1024 sc1 lds
    buffer_load_dwordx4 v3, s[40:43], s8 offen offset:2048 sc1 lds
    buffer_load_dwordx4 v3, s[40:43], s8 offen offset:3072 sc1 lds
    s_add_u32 m0, s9, 32768
    s_nop 0
    buffer_load_dwordx4 v3, s[40:43], s10 offen offset:0 sc1 lds
    buffer_load_dwordx4 v3, s[40:43], s10 offen offset:1024 sc1 lds
    buffer_load_dwordx4 v3, s[40:43], s10 offen offset:2048 sc1 lds
    buffer_load_dwordx4 v3, s[40:43], s10 offen offset:3072 sc1 lds
    v_lshrrev_b32 v4, 5, v1
    v_lshlrev_b32 v4, 4, v4
    s_lshl_b32 s11, s51, 7
    s_add_u32 s11, s11, 38638592
    s_sub_u32 s11, s11, s39
    s_mul_i32 s12, s5, 224
    s_lshl_b32 s13, s51, 1
    s_add_u32 s12, s12, s13
    s_lshl_b32 s12, s12, 10
    s_add_u32 s12, s12, 8552448
    s_add_u32 s13, s12, 114688
    s_waitcnt vmcnt(4)
    s_barrier
    s_cmp_eq_u32 s3, 7
    s_cbranch_scc1 Lly_w7_42
    ds_read_b128 v[48:51], v3 offset:0
    ds_read_b128 v[52:55], v3 offset:1024
    ds_read_b128 v[56:59], v3 offset:2048
    ds_read_b128 v[60:63], v3 offset:3072
    s_waitcnt lgkmcnt(3)
    v_mfma_f32_32x32x16_bf16 v[16:31], v[144:147], v[48:51], 0
    ds_read_b128 v[48:51], v3 offset:4096
    s_waitcnt lgkmcnt(3)
    v_mfma_f32_32x32x16_bf16 v[16:31], v[148:151], v[52:55], v[16:31]
    ds_read_b128 v[52:55], v3 offset:5120
    s_waitcnt lgkmcnt(3)
    v_mfma_f32_32x32x16_bf16 v[16:31], v[152:155], v[56:59], v[16:31]
    s_add_u32 s60, s11, 8192
    buffer_load_dwordx4 v[64:67], v4, s[40:43], s11 offen offset:0
    buffer_load_dwordx4 v[32:35], v4, s[40:43], s60 offen offset:0
    buffer_load_dwordx4 v[68:71], v4, s[40:43], s11 offen offset:32
    buffer_load_dwordx4 v[36:39], v4, s[40:43], s60 offen offset:32
    buffer_load_dwordx4 v[72:75], v4, s[40:43], s11 offen offset:64
    buffer_load_dwordx4 v[40:43], v4, s[40:43], s60 offen offset:64
    buffer_load_dwordx4 v[76:79], v4, s[40:43], s11 offen offset:96
    buffer_load_dwordx4 v[44:47], v4, s[40:43], s60 offen offset:96
    ds_read_b128 v[56:59], v3 offset:6144
    s_waitcnt lgkmcnt(3)
    v_mfma_f32_32x32x16_bf16 v[16:31], v[156:159], v[60:63], v[16:31]
    s_add_u32 s60, s46, 0
    buffer_load_dwordx4 v[120:123], v3, s[40:43], s60 offen offset:3072
    ds_read_b128 v[60:63], v3 offset:7168
    s_waitcnt lgkmcnt(3)
    v_mfma_f32_32x32x16_bf16 v[16:31], v[160:163], v[48:51], v[16:31]
    ds_read_b128 v[48:51], v3 offset:8192
    s_waitcnt lgkmcnt(3)
    v_mfma_f32_32x32x16_bf16 v[16:31], v[164:167], v[52:55], v[16:31]
    ds_read_b128 v[52:55], v3 offset:9216
    s_waitcnt lgkmcnt(3)
    v_mfma_f32_32x32x16_bf16 v[16:31], v[168:171], v[56:59], v[16:31]
    ds_read_b128 v[56:59], v3 offset:10240
    s_waitcnt lgkmcnt(3)
    v_mfma_f32_32x32x16_bf16 v[16:31], v[172:175], v[60:63], v[16:31]
    s_add_u32 s60, s46, 114688
    buffer_load_dwordx4 v[124:127], v3, s[40:43], s60 offen offset:3072
    ds_read_b128 v[60:63], v3 offset:11264
    s_waitcnt lgkmcnt(3)
    v_mfma_f32_32x32x16_bf16 v[16:31], v[176:179], v[48:51], v[16:31]
    ds_read_b128 v[48:51], v3 offset:12288
    s_waitcnt lgkmcnt(3)
    v_mfma_f32_32x32x16_bf16 v[16:31], v[180:183], v[52:55], v[16:31]
    ds_read_b128 v[52:55], v3 offset:13312
    s_waitcnt lgkmcnt(3)
    v_mfma_f32_32x32x16_bf16 v[16:31], v[184:187], v[56:59], v[16:31]
    ds_read_b128 v[56:59], v3 offset:14336
    s_waitcnt lgkmcnt(3)
    v_mfma_f32_32x32x16_bf16 v[16:31], v[188:191], v[60:63], v[16:31]
    s_add_u32 s60, s46, 4096
    buffer_load_dwordx4 v[128:131], v3, s[40:43], s60 offen offset:0
    ds_read_b128 v[60:63], v3 offset:15360
    s_waitcnt lgkmcnt(3)
    v_mfma_f32_32x32x16_bf16 v[16:31], v[192:195], v[48:51], v[16:31]
    ds_read_b128 v[48:51], v3 offset:16384
    s_waitcnt lgkmcnt(3)
    v_mfma_f32_32x32x16_bf16 v[16:31], v[196:199], v[52:55], v[16:31]
    ds_read_b128 v[52:55], v3 offset:17408
    s_waitcnt lgkmcnt(3)
    v_mfma_f32_32x32x16_bf16 v[16:31], v[200:203], v[56:59], v[16:31]
    ds_read_b128 v[56:59], v3 offset:18432
    s_waitcnt lgkmcnt(3)
    v_mfma_f32_32x32x16_bf16 v[16:31], v[204:207], v[60:63], v[16:31]
    s_add_u32 s60, s46, 118784
    buffer_load_dwordx4 v[132:135], v3, s[40:43], s60 offen offset:0
    ds_read_b128 v[60:63], v3 offset:19456
    s_waitcnt lgkmcnt(3)
    v_mfma_f32_32x32x16_bf16 v[16:31], v[208:211], v[48:51], v[16:31]
    ds_read_b128 v[48:51], v3 offset:20480
    s_waitcnt lgkmcnt(3)
    v_mfma_f32_32x32x16_bf16 v[16:31], v[212:215], v[52:55], v[16:31]
    ds_read_b128 v[52:55], v3 offset:21504
    s_waitcnt lgkmcnt(3)
    v_mfma_f32_32x32x16_bf16 v[16:31], v[216:219], v[56:59], v[16:31]
    ds_read_b128 v[56:59], v3 offset:22528
    s_waitcnt lgkmcnt(3)
    v_mfma_f32_32x32x16_bf16 v[16:31], v[220:223], v[60:63], v[16:31]
    s_add_u32 s60, s46, 4096
    buffer_load_dwordx4 v[136:139], v3, s[40:43], s60 offen offset:1024
    ds_read_b128 v[60:63], v3 offset:23552
    s_waitcnt lgkmcnt(3)
    v_mfma_f32_32x32x16_bf16 v[16:31], v[224:227], v[48:51], v[16:31]
    ds_read_b128 v[48:51], v3 offset:24576
    s_waitcnt lgkmcnt(3)
    v_mfma_f32_32x32x16_bf16 v[16:31], v[228:231], v[52:55], v[16:31]
    ds_read_b128 v[52:55], v3 offset:25600
    s_waitcnt lgkmcnt(3)
    v_mfma_f32_32x32x16_bf16 v[16:31], v[232:235], v[56:59], v[16:31]
    ds_read_b128 v[56:59], v3 offset:26624
    s_waitcnt lgkmcnt(3)
    v_mfma_f32_32x32x16_bf16 v[16:31], v[236:239], v[60:63], v[16:31]
    s_add_u32 s60, s46, 118784
    buffer_load_dwordx4 v[140:143], v3, s[40:43], s60 offen offset:1024
    ds_read_b128 v[60:63], v3 offset:27648
    s_waitcnt lgkmcnt(3)
    v_mfma_f32_32x32x16_bf16 v[16:31], v[240:243], v[48:51], v[16:31]
    ds_read_b128 v[48:51], v3 offset:28672
    s_waitcnt lgkmcnt(3)
    v_mfma_f32_32x32x16_bf16 v[16:31], v[244:247], v[52:55], v[16:31]
    ds_read_b128 v[52:55], v3 offset:29696
    s_waitcnt lgkmcnt(3)
    v_mfma_f32_32x32x16_bf16 v[16:31], v[248:251], v[56:59], v[16:31]
    ds_read_b128 v[56:59], v3 offset:30720
    s_waitcnt lgkmcnt(3)
    v_mfma_f32_32x32x16_bf16 v[16:31], v[252:255], v[60:63], v[16:31]
    ds_read_b128 v[60:63], v3 offset:31744
    s_waitcnt lgkmcnt(3)
    v_mfma_f32_32x32x16_bf16 v[16:31], v[80:83], v[48:51], v[16:31]
    s_waitcnt lgkmcnt(2)
    v_mfma_f32_32x32x16_bf16 v[16:31], v[84:87], v[52:55], v[16:31]
    s_waitcnt lgkmcnt(1)
    v_mfma_f32_32x32x16_bf16 v[16:31], v[88:91], v[56:59], v[16:31]
    s_waitcnt lgkmcnt(0)
    v_mfma_f32_32x32x16_bf16 v[16:31], v[92:95], v[60:63], v[16:31]
    v_and_b32 v5, 31, v1
    v_lshlrev_b32 v5, 4, v5
    v_add_u32 v5, 135168, v5
    s_waitcnt vmcnt(6)
    v_add_f32 v64, v64, v32
    v_add_f32 v65, v65, v33
    v_add_f32 v66, v66, v34
    v_add_f32 v67, v67, v35
    v_add_f32 v68, v68, v36
    v_add_f32 v69, v69, v37
    v_add_f32 v70, v70, v38
    v_add_f32 v71, v71, v39
    v_add_f32 v72, v72, v40
    v_add_f32 v73, v73, v41
    v_add_f32 v74, v74, v42
    v_add_f32 v75, v75, v43
    v_add_f32 v76, v76, v44
    v_add_f32 v77, v77, v45
    v_add_f32 v78, v78, v46
    v_add_f32 v79, v79, v47
    s_barrier
    ds_read_b128 v[8:11], v5
    ds_read_b128 v[48:51], v3 offset:32768
    ds_read_b128 v[52:55], v3 offset:33792
    ds_read_b128 v[56:59], v3 offset:34816
    ds_read_b128 v[60:63], v3 offset:35840
    s_waitcnt lgkmcnt(3)
    v_mfma_f32_32x32x16_bf16 v[32:47], v[144:147], v[48:51], 0
    s_add_u32 s60, s46, 4096
    buffer_load_dwordx4 v[144:147], v3, s[40:43], s60 offen offset:2048
    v_mul_f32 v16, v9, v16
    v_fma_f32 v16, -v8, v64, v16
    v_mul_f32 v17, v9, v17
    ds_read_b128 v[48:51], v3 offset:36864
    s_waitcnt lgkmcnt(3)
    v_mfma_f32_32x32x16_bf16 v[32:47], v[148:151], v[52:55], v[32:47]
    s_add_u32 s60, s46, 118784
    buffer_load_dwordx4 v[148:151], v3, s[40:43], s60 offen offset:2048
    v_fma_f32 v17, -v8, v65, v17
    v_mul_f32 v18, v9, v18
    v_fma_f32 v18, -v8, v66, v18
    ds_read_b128 v[52:55], v3 offset:37888
    s_waitcnt lgkmcnt(3)
    v_mfma_f32_32x32x16_bf16 v[32:47], v[152:155], v[56:59], v[32:47]
    v_mul_f32 v19, v9, v19
    v_fma_f32 v19, -v8, v67, v19
    v_mul_f32 v20, v9, v20
    ds_read_b128 v[56:59], v3 offset:38912
    s_waitcnt lgkmcnt(3)
    v_mfma_f32_32x32x16_bf16 v[32:47], v[156:159], v[60:63], v[32:47]
    s_add_u32 s60, s46, 4096
    buffer_load_dwordx4 v[152:155], v3, s[40:43], s60 offen offset:3072
    v_fma_f32 v20, -v8, v68, v20
    v_mul_f32 v21, v9, v21
    v_fma_f32 v21, -v8, v69, v21
    ds_read_b128 v[60:63], v3 offset:39936
    s_waitcnt lgkmcnt(3)
    v_mfma_f32_32x32x16_bf16 v[32:47], v[160:163], v[48:51], v[32:47]
    s_add_u32 s60, s46, 118784
    buffer_load_dwordx4 v[156:159], v3, s[40:43], s60 offen offset:3072
    v_mul_f32 v22, v9, v22
    v_fma_f32 v22, -v8, v70, v22
    v_mul_f32 v23, v9, v23
    ds_read_b128 v[48:51], v3 offset:40960
    s_waitcnt lgkmcnt(3)
    v_mfma_f32_32x32x16_bf16 v[32:47], v[164:167], v[52:55], v[32:47]
    v_fma_f32 v23, -v8, v71, v23
    v_mul_f32 v24, v9, v24
    v_fma_f32 v24, -v8, v72, v24
    ds_read_b128 v[52:55], v3 offset:41984
    s_waitcnt lgkmcnt(3)
    v_mfma_f32_32x32x16_bf16 v[32:47], v[168:171], v[56:59], v[32:47]
    s_add_u32 s60, s46, 8192
    buffer_load_dwordx4 v[160:163], v3, s[40:43], s60 offen offset:0
    v_mul_f32 v25, v9, v25
    v_fma_f32 v25, -v8, v73, v25
    v_mul_f32 v26, v9, v26
    ds_read_b128 v[56:59], v3 offset:43008
    s_waitcnt lgkmcnt(3)
    v_mfma_f32_32x32x16_bf16 v[32:47], v[172:175], v[60:63], v[32:47]
    s_add_u32 s60, s46, 122880
    buffer_load_dwordx4 v[164:167], v3, s[40:43], s60 offen offset:0
    v_fma_f32 v26, -v8, v74, v26
    v_mul_f32 v27, v9, v27
    v_fma_f32 v27, -v8, v75, v27
    ds_read_b128 v[60:63], v3 offset:44032
    s_waitcnt lgkmcnt(3)
    v_mfma_f32_32x32x16_bf16 v[32:47], v[176:179], v[48:51], v[32:47]
    v_mul_f32 v28, v9, v28
    v_fma_f32 v28, -v8, v76, v28
    v_mul_f32 v29, v9, v29
    ds_read_b128 v[48:51], v3 offset:45056
    s_waitcnt lgkmcnt(3)
    v_mfma_f32_32x32x16_bf16 v[32:47], v[180:183], v[52:55], v[32:47]
    s_add_u32 s60, s46, 8192
    buffer_load_dwordx4 v[168:171], v3, s[40:43], s60 offen offset:1024
    v_fma_f32 v29, -v8, v77, v29
    v_mul_f32 v30, v9, v30
    v_fma_f32 v30, -v8, v78, v30
    ds_read_b128 v[52:55], v3 offset:46080
    s_waitcnt lgkmcnt(3)
    v_mfma_f32_32x32x16_bf16 v[32:47], v[184:187], v[56:59], v[32:47]
    s_add_u32 s60, s46, 122880
    buffer_load_dwordx4 v[172:175], v3, s[40:43], s60 offen offset:1024
    v_mul_f32 v31, v9, v31
    v_fma_f32 v31, -v8, v79, v31
    v_cvt_pk_bf16_f32 v4, v16, v17
    ds_read_b128 v[56:59], v3 offset:47104
    s_waitcnt lgkmcnt(3)
    v_mfma_f32_32x32x16_bf16 v[32:47], v[188:191], v[60:63], v[32:47]
    v_cvt_pk_bf16_f32 v5, v18, v19
    v_cvt_pk_bf16_f32 v6, v20, v21
    v_cvt_pk_bf16_f32 v7, v22, v23
    ds_read_b128 v[60:63], v3 offset:48128
    s_waitcnt lgkmcnt(3)
    v_mfma_f32_32x32x16_bf16 v[32:47], v[192:195], v[48:51], v[32:47]
    s_add_u32 s60, s46, 8192
    buffer_load_dwordx4 v[176:179], v3, s[40:43], s60 offen offset:2048
    v_cvt_pk_bf16_f32 v12, v24, v25
    v_cvt_pk_bf16_f32 v13, v26, v27
    v_cvt_pk_bf16_f32 v14, v28, v29
    ds_read_b128 v[48:51], v3 offset:49152
    s_waitcnt lgkmcnt(3)
    v_mfma_f32_32x32x16_bf16 v[32:47], v[196:199], v[52:55], v[32:47]
    s_add_u32 s60, s46, 122880
    buffer_load_dwordx4 v[180:183], v3, s[40:43], s60 offen offset:2048
    v_cvt_pk_bf16_f32 v15, v30, v31
    v_pk_max_i16 v4, v4, 0
    v_pk_max_i16 v5, v5, 0
    ds_read_b128 v[52:55], v3 offset:50176
    s_waitcnt lgkmcnt(3)
    v_mfma_f32_32x32x16_bf16 v[32:47], v[200:203], v[56:59], v[32:47]
    v_pk_max_i16 v6, v6, 0
    v_pk_max_i16 v7, v7, 0
    v_pk_max_i16 v12, v12, 0
    ds_read_b128 v[56:59], v3 offset:51200
    s_waitcnt lgkmcnt(3)
    v_mfma_f32_32x32x16_bf16 v[32:47], v[204:207], v[60:63], v[32:47]
    s_add_u32 s60, s46, 8192
    buffer_load_dwordx4 v[184:187], v3, s[40:43], s60 offen offset:3072
    v_pk_max_i16 v13, v13, 0
    v_pk_max_i16 v14, v14, 0
    v_pk_max_i16 v15, v15, 0
    buffer_store_dwordx4 v[4:7], v3, s[40:43], s12 offen sc1
    buffer_store_dwordx4 v[12:15], v3, s[40:43], s12 offen offset:1024 sc1
    ds_read_b128 v[60:63], v3 offset:52224
    s_waitcnt lgkmcnt(3)
    v_mfma_f32_32x32x16_bf16 v[32:47], v[208:211], v[48:51], v[32:47]
    s_add_u32 s60, s46, 122880
    buffer_load_dwordx4 v[188:191], v3, s[40:43], s60 offen offset:3072
    ds_read_b128 v[48:51], v3 offset:53248
    s_waitcnt lgkmcnt(3)
    v_mfma_f32_32x32x16_bf16 v[32:47], v[212:215], v[52:55], v[32:47]
    ds_read_b128 v[52:55], v3 offset:54272
    s_waitcnt lgkmcnt(3)
    v_mfma_f32_32x32x16_bf16 v[32:47], v[216:219], v[56:59], v[32:47]
    s_add_u32 s60, s46, 12288
    buffer_load_dwordx4 v[192:195], v3, s[40:43], s60 offen offset:0
    ds_read_b128 v[56:59], v3 offset:55296
    s_waitcnt lgkmcnt(3)
    v_mfma_f32_32x32x16_bf16 v[32:47], v[220:223], v[60:63], v[32:47]
    s_add_u32 s60, s46, 126976
    buffer_load_dwordx4 v[196:199], v3, s[40:43], s60 offen offset:0
    ds_read_b128 v[60:63], v3 offset:56320
    s_waitcnt lgkmcnt(3)
    v_mfma_f32_32x32x16_bf16 v[32:47], v[224:227], v[48:51], v[32:47]
    ds_read_b128 v[48:51], v3 offset:57344
    s_waitcnt lgkmcnt(3)
    v_mfma_f32_32x32x16_bf16 v[32:47], v[228:231], v[52:55], v[32:47]
    s_add_u32 s60, s46, 12288
    buffer_load_dwordx4 v[200:203], v3, s[40:43], s60 offen offset:1024
    ds_read_b128 v[52:55], v3 offset:58368
    s_waitcnt lgkmcnt(3)
    v_mfma_f32_32x32x16_bf16 v[32:47], v[232:235], v[56:59], v[32:47]
    s_add_u32 s60, s46, 126976
    buffer_load_dwordx4 v[204:207], v3, s[40:43], s60 offen offset:1024
    ds_read_b128 v[56:59], v3 offset:59392
    s_waitcnt lgkmcnt(3)
    v_mfma_f32_32x32x16_bf16 v[32:47], v[236:239], v[60:63], v[32:47]
    ds_read_b128 v[60:63], v3 offset:60416
    s_waitcnt lgkmcnt(3)
    v_mfma_f32_32x32x16_bf16 v[32:47], v[240:243], v[48:51], v[32:47]
    ds_read_b128 v[48:51], v3 offset:61440
    s_waitcnt lgkmcnt(3)
    v_mfma_f32_32x32x16_bf16 v[32:47], v[244:247], v[52:55], v[32:47]
    ds_read_b128 v[52:55], v3 offset:62464
    s_waitcnt lgkmcnt(3)
    v_mfma_f32_32x32x16_bf16 v[32:47], v[248:251], v[56:59], v[32:47]
    ds_read_b128 v[56:59], v3 offset:63488
    s_waitcnt lgkmcnt(3)
    v_mfma_f32_32x32x16_bf16 v[32:47], v[252:255], v[60:63], v[32:47]
    ds_read_b128 v[60:63], v3 offset:64512
    s_waitcnt lgkmcnt(3)
    v_mfma_f32_32x32x16_bf16 v[32:47], v[80:83], v[48:51], v[32:47]
    s_waitcnt lgkmcnt(2)
    v_mfma_f32_32x32x16_bf16 v[32:47], v[84:87], v[52:55], v[32:47]
    s_waitcnt lgkmcnt(1)
    v_mfma_f32_32x32x16_bf16 v[32:47], v[88:91], v[56:59], v[32:47]
    s_waitcnt lgkmcnt(0)
    v_mfma_f32_32x32x16_bf16 v[32:47], v[92:95], v[60:63], v[32:47]
    s_nop 13
    v_mul_f32 v32, v11, v32
    v_fma_f32 v32, -v10, v64, v32
    v_mul_f32 v33, v11, v33
    v_fma_f32 v33, -v10, v65, v33
    v_mul_f32 v34, v11, v34
    v_fma_f32 v34, -v10, v66, v34
    v_mul_f32 v35, v11, v35
    v_fma_f32 v35, -v10, v67, v35
    v_mul_f32 v36, v11, v36
    v_fma_f32 v36, -v10, v68, v36
    v_mul_f32 v37, v11, v37
    v_fma_f32 v37, -v10, v69, v37
    v_mul_f32 v38, v11, v38
    v_fma_f32 v38, -v10, v70, v38
    v_mul_f32 v39, v11, v39
    v_fma_f32 v39, -v10, v71, v39
    v_mul_f32 v40, v11, v40
    v_fma_f32 v40, -v10, v72, v40
    v_mul_f32 v41, v11, v41
    v_fma_f32 v41, -v10, v73, v41
    v_mul_f32 v42, v11, v42
    v_fma_f32 v42, -v10, v74, v42
    v_mul_f32 v43, v11, v43
    v_fma_f32 v43, -v10, v75, v43
    v_mul_f32 v44, v11, v44
    v_fma_f32 v44, -v10, v76, v44
    v_mul_f32 v45, v11, v45
    v_fma_f32 v45, -v10, v77, v45
    v_mul_f32 v46, v11, v46
    v_fma_f32 v46, -v10, v78, v46
    v_mul_f32 v47, v11, v47
    v_fma_f32 v47, -v10, v79, v47
    v_cvt_pk_bf16_f32 v4, v32, v33
    v_cvt_pk_bf16_f32 v5, v34, v35
    v_cvt_pk_bf16_f32 v6, v36, v37
    v_cvt_pk_bf16_f32 v7, v38, v39
    v_cvt_pk_bf16_f32 v12, v40, v41
    v_cvt_pk_bf16_f32 v13, v42, v43
    v_cvt_pk_bf16_f32 v14, v44, v45
    v_cvt_pk_bf16_f32 v15, v46, v47
    v_pk_max_i16 v4, v4, 0
    v_pk_max_i16 v5, v5, 0
    v_pk_max_i16 v6, v6, 0
    v_pk_max_i16 v7, v7, 0
    v_pk_max_i16 v12, v12, 0
    v_pk_max_i16 v13, v13, 0
    v_pk_max_i16 v14, v14, 0
    v_pk_max_i16 v15, v15, 0
    buffer_store_dwordx4 v[4:7], v3, s[40:43], s13 offen sc1
    buffer_store_dwordx4 v[12:15], v3, s[40:43], s13 offen offset:1024 sc1
    s_branch Lly_f1e_43
Lly_w7_42:
    v_and_b32 v5, 31, v1
    v_lshlrev_b32 v5, 3, v5
    v_lshrrev_b32 v6, 5, v1
    v_lshl_add_u32 v5, v6, 12, v5
    s_lshl_b32 s60, s5, 14
    s_add_u32 s60, s60, 15892480
    s_add_u32 s61, s60, 8192
    buffer_load_dwordx2 v[16:17], v5, s[40:43], s60 offen offset:0 sc1
    buffer_load_dwordx2 v[18:19], v5, s[40:43], s60 offen offset:256 sc1
    buffer_load_dwordx2 v[20:21], v5, s[40:43], s60 offen offset:512 sc1
    buffer_load_dwordx2 v[22:23], v5, s[40:43], s60 offen offset:768 sc1
    buffer_load_dwordx2 v[24:25], v5, s[40:43], s60 offen offset:1024 sc1
    buffer_load_dwordx2 v[26:27], v5, s[40:43], s60 offen offset:1280 sc1
    buffer_load_dwordx2 v[28:29], v5, s[40:43], s60 offen offset:1536 sc1
    buffer_load_dwordx2 v[30:31], v5, s[40:43], s60 offen offset:1792 sc1
    buffer_load_dwordx2 v[32:33], v5, s[40:43], s60 offen offset:2048 sc1
    buffer_load_dwordx2 v[34:35], v5, s[40:43], s60 offen offset:2304 sc1
    buffer_load_dwordx2 v[36:37], v5, s[40:43], s60 offen offset:2560 sc1
    buffer_load_dwordx2 v[38:39], v5, s[40:43], s60 offen offset:2816 sc1
    buffer_load_dwordx2 v[40:41], v5, s[40:43], s60 offen offset:3072 sc1
    buffer_load_dwordx2 v[42:43], v5, s[40:43], s60 offen offset:3328 sc1
    buffer_load_dwordx2 v[44:45], v5, s[40:43], s60 offen offset:3584 sc1
    buffer_load_dwordx2 v[46:47], v5, s[40:43], s60 offen offset:3840 sc1
    buffer_load_dwordx2 v[48:49], v5, s[40:43], s61 offen offset:0 sc1
    buffer_load_dwordx2 v[50:51], v5, s[40:43], s61 offen offset:256 sc1
    buffer_load_dwordx2 v[52:53], v5, s[40:43], s61 offen offset:512 sc1
    buffer_load_dwordx2 v[54:55], v5, s[40:43], s61 offen offset:768 sc1
    buffer_load_dwordx2 v[56:57], v5, s[40:43], s61 offen offset:1024 sc1
    buffer_load_dwordx2 v[58:59], v5, s[40:43], s61 offen offset:1280 sc1
    buffer_load_dwordx2 v[60:61], v5, s[40:43], s61 offen offset:1536 sc1
    buffer_load_dwordx2 v[62:63], v5, s[40:43], s61 offen offset:1792 sc1
    buffer_load_dwordx2 v[64:65], v5, s[40:43], s61 offen offset:2048 sc1
    buffer_load_dwordx2 v[66:67], v5, s[40:43], s61 offen offset:2304 sc1
    buffer_load_dwordx2 v[68:69], v5, s[40:43], s61 offen offset:2560 sc1
    buffer_load_dwordx2 v[70:71], v5, s[40:43], s61 offen offset:2816 sc1
    buffer_load_dwordx2 v[72:73], v5, s[40:43], s61 offen offset:3072 sc1
    buffer_load_dwordx2 v[74:75], v5, s[40:43], s61 offen offset:3328 sc1
    buffer_load_dwordx2 v[76:77], v5, s[40:43], s61 offen offset:3584 sc1
    buffer_load_dwordx2 v[78:79], v5, s[40:43], s61 offen offset:3840 sc1
    s_waitcnt vmcnt(0)
    v_add_f32 v16, v16, v18
    v_add_f32 v17, v17, v19
    v_add_f32 v16, v16, v20
    v_add_f32 v17, v17, v21
    v_add_f32 v16, v16, v22
    v_add_f32 v17, v17, v23
    v_add_f32 v16, v16, v24
    v_add_f32 v17, v17, v25
    v_add_f32 v16, v16, v26
    v_add_f32 v17, v17, v27
    v_add_f32 v16, v16, v28
    v_add_f32 v17, v17, v29
    v_add_f32 v16, v16, v30
    v_add_f32 v17, v17, v31
    v_add_f32 v16, v16, v32
    v_add_f32 v17, v17, v33
    v_add_f32 v16, v16, v34
    v_add_f32 v17, v17, v35
    v_add_f32 v16, v16, v36
    v_add_f32 v17, v17, v37
    v_add_f32 v16, v16, v38
    v_add_f32 v17, v17, v39
    v_add_f32 v16, v16, v40
    v_add_f32 v17, v17, v41
    v_add_f32 v16, v16, v42
    v_add_f32 v17, v17, v43
    v_add_f32 v16, v16, v44
    v_add_f32 v17, v17, v45
    v_add_f32 v16, v16, v46
    v_add_f32 v17, v17, v47
    v_add_f32 v48, v48, v50
    v_add_f32 v49, v49, v51
    v_add_f32 v48, v48, v52
    v_add_f32 v49, v49, v53
    v_add_f32 v48, v48, v54
    v_add_f32 v49, v49, v55
    v_add_f32 v48, v48, v56
    v_add_f32 v49, v49, v57
    v_add_f32 v48, v48, v58
    v_add_f32 v49, v49, v59
    v_add_f32 v48, v48, v60
    v_add_f32 v49, v49, v61
    v_add_f32 v48, v48, v62
    v_add_f32 v49, v49, v63
    v_add_f32 v48, v48, v64
    v_add_f32 v49, v49, v65
    v_add_f32 v48, v48, v66
    v_add_f32 v49, v49, v67
    v_add_f32 v48, v48, v68
    v_add_f32 v49, v49, v69
    v_add_f32 v48, v48, v70
    v_add_f32 v49, v49, v71
    v_add_f32 v48, v48, v72
    v_add_f32 v49, v49, v73
    v_add_f32 v48, v48, v74
    v_add_f32 v49, v49, v75
    v_add_f32 v48, v48, v76
    v_add_f32 v49, v49, v77
    v_add_f32 v48, v48, v78
    v_add_f32 v49, v49, v79
    v_mov_b32 v4, v16
    v_mov_b32 v6, v17
    v_mov_b32 v8, v48
    v_mov_b32 v10, v49
    v_mov_b32 v12, v16
    v_mov_b32 v13, v17
    v_mov_b32 v14, v48
    v_mov_b32 v15, v49
    s_nop 1
    v_permlane32_swap_b32 v4, v12
    v_permlane32_swap_b32 v6, v13
    v_permlane32_swap_b32 v8, v14
    v_permlane32_swap_b32 v10, v15
    s_nop 1
    v_add_f32 v4, v4, v12
    v_add_f32 v6, v6, v13
    v_add_f32 v8, v8, v14
    v_add_f32 v10, v10, v15
    v_mul_f32 v12, 0x3b000000, v4
    v_mul_f32 v13, 0x3b000000, v6
    v_fma_f32 v13, -v12, v12, v13
    v_max_f32 v13, 0, v13
    v_cvt_pk_bf16_f32 v16, v12, v12
    v_lshlrev_b32 v16, 16, v16
    v_cvt_pk_bf16_f32 v13, v13, v13
    v_lshlrev_b32 v13, 16, v13
    v_add_f32 v13, 0x3727c5ac, v13
    v_cvt_pk_bf16_f32 v13, v13, v13
    v_lshlrev_b32 v13, 16, v13
    v_sqrt_f32 v13, v13
    s_nop 0
    v_cvt_pk_bf16_f32 v13, v13, v13
    v_lshlrev_b32 v13, 16, v13
    v_rcp_f32 v17, v13
    s_nop 0
    v_mul_f32 v12, 0x3b000000, v8
    v_mul_f32 v13, 0x3b000000, v10
    v_fma_f32 v13, -v12, v12, v13
    v_max_f32 v13, 0, v13
    v_cvt_pk_bf16_f32 v18, v12, v12
    v_lshlrev_b32 v18, 16, v18
    v_cvt_pk_bf16_f32 v13, v13, v13
    v_lshlrev_b32 v13, 16, v13
    v_add_f32 v13, 0x3727c5ac, v13
    v_cvt_pk_bf16_f32 v13, v13, v13
    v_lshlrev_b32 v13, 16, v13
    v_sqrt_f32 v13, v13
    s_nop 0
    v_cvt_pk_bf16_f32 v13, v13, v13
    v_lshlrev_b32 v13, 16, v13
    v_rcp_f32 v19, v13
    s_nop 0
    v_mul_f32 v16, v16, v17
    v_mul_f32 v18, v18, v19
    v_and_b32 v5, 31, v1
    v_lshlrev_b32 v5, 4, v5
    v_add_u32 v5, 135168, v5
    ds_write_b128 v5, v[16:19]
    s_waitcnt vmcnt(0) lgkmcnt(0)
    s_barrier
    s_add_u32 s60, s46, 0
    buffer_load_dwordx4 v[120:123], v3, s[40:43], s60 offen offset:3072
    s_add_u32 s60, s46, 114688
    buffer_load_dwordx4 v[124:127], v3, s[40:43], s60 offen offset:3072
    s_add_u32 s60, s46, 4096
    buffer_load_dwordx4 v[128:131], v3, s[40:43], s60 offen offset:0
    s_add_u32 s60, s46, 118784
    buffer_load_dwordx4 v[132:135], v3, s[40:43], s60 offen offset:0
    s_add_u32 s60, s46, 4096
    buffer_load_dwordx4 v[136:139], v3, s[40:43], s60 offen offset:1024
    s_add_u32 s60, s46, 118784
    buffer_load_dwordx4 v[140:143], v3, s[40:43], s60 offen offset:1024
    s_add_u32 s60, s46, 4096
    buffer_load_dwordx4 v[144:147], v3, s[40:43], s60 offen offset:2048
    s_add_u32 s60, s46, 118784
    buffer_load_dwordx4 v[148:151], v3, s[40:43], s60 offen offset:2048
    s_add_u32 s60, s46, 4096
    buffer_load_dwordx4 v[152:155], v3, s[40:43], s60 offen offset:3072
    s_add_u32 s60, s46, 118784
    buffer_load_dwordx4 v[156:159], v3, s[40:43], s60 offen offset:3072
    s_add_u32 s60, s46, 8192
    buffer_load_dwordx4 v[160:163], v3, s[40:43], s60 offen offset:0
    s_add_u32 s60, s46, 122880
    buffer_load_dwordx4 v[164:167], v3, s[40:43], s60 offen offset:0
    s_add_u32 s60, s46, 8192
    buffer_load_dwordx4 v[168:171], v3, s[40:43], s60 offen offset:1024
    s_add_u32 s60, s46, 122880
    buffer_load_dwordx4 v[172:175], v3, s[40:43], s60 offen offset:1024
    s_add_u32 s60, s46, 8192
    buffer_load_dwordx4 v[176:179], v3, s[40:43], s60 offen offset:2048
    s_add_u32 s60, s46, 122880
    buffer_load_dwordx4 v[180:183], v3, s[40:43], s60 offen offset:2048
    s_add_u32 s60, s46, 8192
    buffer_load_dwordx4 v[184:187], v3, s[40:43], s60 offen offset:3072
    s_add_u32 s60, s46, 122880
    buffer_load_dwordx4 v[188:191], v3, s[40:43], s60 offen offset:3072
    s_add_u32 s60, s46, 12288
    buffer_load_dwordx4 v[192:195], v3, s[40:43], s60 offen offset:0
    s_add_u32 s60, s46, 126976
    buffer_load_dwordx4 v[196:199], v3, s[40:43], s60 offen offset:0
    s_add_u32 s60, s46, 12288
    buffer_load_dwordx4 v[200:203], v3, s[40:43], s60 offen offset:1024
    s_add_u32 s60, s46, 126976
    buffer_load_dwordx4 v[204:207], v3, s[40:43], s60 offen offset:1024
Lly_f1e_43:
    s_waitcnt vmcnt(0)
    s_barrier
    s_cmp_lg_u32 s3, 7
    s_cbranch_scc1 Lly_sig_44
    s_lshl_b32 s60, s5, 7
    s_lshl_b32 s61, s6, 2
    s_add_u32 s60, s60, s61
    s_add_u32 s60, s60, 8192
    v_mov_b32 v4, 1
    v_mov_b32 v5, 0
    s_mov_b64 exec, 1
    s_cmp_eq_u32 s52, 1
    s_cbranch_scc1 Lly_hs_45
    buffer_store_dword v4, v5, s[40:43], s60 offen sc1
    s_branch Lly_he_46
Lly_hs_45:
    buffer_store_dword v4, v5, s[40:43], s60 offen
Lly_he_46:
    s_mov_b64 exec, -1
Lly_sig_44:
    s_lshl_b32 s60, s5, 7
    s_lshl_b32 s61, s3, 2
    s_add_u32 s60, s60, s61
    s_add_u32 s60, s60, 8192
    v_mov_b32 v5, 0
    s_mov_b32 s61, 0
    s_mov_b64 exec, 1
Lly_wp_47:
    buffer_load_dword v4, v5, s[40:43], s60 offen sc1
    s_waitcnt vmcnt(0)
    v_readfirstlane_b32 s62, v4
    s_cmp_eq_u32 s62, 1
    s_cbranch_scc1 Lly_wd_48
    s_add_u32 s61, s61, 1
    s_cmp_ge_u32 s61, 0x400000
    s_cbranch_scc1 Lly_wd_48
    s_sleep 1
    s_branch Lly_wp_47
Lly_wd_48:
    s_mov_b64 exec, -1
    s_mul_i32 s9, s3, 14336
    s_mul_i32 s10, s5, 229376
    s_add_u32 s10, s10, s9
    s_add_u32 s10, s10, 8552448
    s_add_u32 s11, s10, 114688
    s_lshr_b32 s60, s3, 1
    s_and_b32 s56, s60, 1
    s_lshl_b32 s61, s5, 1
    s_add_u32 s56, s56, s61
    s_lshr_b32 s57, s3, 2
    s_lshl_b32 s61, s6, 1
    s_add_u32 s57, s57, s61
    s_lshl_b32 s57, s57, 1
    s_and_b32 s61, s3, 1
    s_add_u32 s57, s57, s61
    s_lshl_b32 s58, s56, 5
    s_add_u32 s58, s58, s57
    s_lshl_b32 s58, s58, 10
    s_add_u32 s58, s58, 0
    s_add_u32 s59, s58, 17104896
    s_add_u32 s58, s58, 2260992
    buffer_load_dwordx4 v[12:15], v3, s[40:43], s58 offen sc1
    buffer_load_dwordx4 v[208:211], v3, s[40:43], s10 offen offset:0 sc1
    buffer_load_dwordx4 v[212:215], v3, s[40:43], s11 offen offset:0 sc1
    buffer_load_dwordx4 v[216:219], v3, s[40:43], s10 offen offset:1024 sc1
    buffer_load_dwordx4 v[220:223], v3, s[40:43], s11 offen offset:1024 sc1
    buffer_load_dwordx4 v[224:227], v3, s[40:43], s10 offen offset:2048 sc1
    buffer_load_dwordx4 v[228:231], v3, s[40:43], s11 offen offset:2048 sc1
    buffer_load_dwordx4 v[232:235], v3, s[40:43], s10 offen offset:3072 sc1
    buffer_load_dwordx4 v[236:239], v3, s[40:43], s11 offen offset:3072 sc1
    s_add_u32 s10, s10, 4096
    s_add_u32 s11, s11, 4096
    s_waitcnt vmcnt(6)
    v_mfma_f32_32x32x16_bf16 v[16:31], v[96:99], v[208:211], 0
    v_mfma_f32_32x32x16_bf16 v[32:47], v[96:99], v[212:215], 0
    v_mfma_f32_32x32x16_bf16 v[48:63], v[100:103], v[208:211], 0
    v_mfma_f32_32x32x16_bf16 v[64:79], v[100:103], v[212:215], 0
    buffer_load_dwordx4 v[208:211], v3, s[40:43], s10 offen offset:0 sc1
    buffer_load_dwordx4 v[212:215], v3, s[40:43], s11 offen offset:0 sc1
    s_waitcnt vmcnt(6)
    v_mfma_f32_32x32x16_bf16 v[16:31], v[104:107], v[216:219], v[16:31]
    v_mfma_f32_32x32x16_bf16 v[32:47], v[104:107], v[220:223], v[32:47]
    v_mfma_f32_32x32x16_bf16 v[48:63], v[108:111], v[216:219], v[48:63]
    v_mfma_f32_32x32x16_bf16 v[64:79], v[108:111], v[220:223], v[64:79]
    buffer_load_dwordx4 v[216:219], v3, s[40:43], s10 offen offset:1024 sc1
    buffer_load_dwordx4 v[220:223], v3, s[40:43], s11 offen offset:1024 sc1
    s_waitcnt vmcnt(6)
    v_mfma_f32_32x32x16_bf16 v[16:31], v[112:115], v[224:227], v[16:31]
    v_mfma_f32_32x32x16_bf16 v[32:47], v[112:115], v[228:231], v[32:47]
    v_mfma_f32_32x32x16_bf16 v[48:63], v[116:119], v[224:227], v[48:63]
    v_mfma_f32_32x32x16_bf16 v[64:79], v[116:119], v[228:231], v[64:79]
    buffer_load_dwordx4 v[224:227], v3, s[40:43], s10 offen offset:2048 sc1
    buffer_load_dwordx4 v[228:231], v3, s[40:43], s11 offen offset:2048 sc1
    s_waitcnt vmcnt(6)
    v_mfma_f32_32x32x16_bf16 v[16:31], v[120:123], v[232:235], v[16:31]
    v_mfma_f32_32x32x16_bf16 v[32:47], v[120:123], v[236:239], v[32:47]
    v_mfma_f32_32x32x16_bf16 v[48:63], v[124:127], v[232:235], v[48:63]
    v_mfma_f32_32x32x16_bf16 v[64:79], v[124:127], v[236:239], v[64:79]
    buffer_load_dwordx4 v[232:235], v3, s[40:43], s10 offen offset:3072 sc1
    buffer_load_dwordx4 v[236:239], v3, s[40:43], s11 offen offset:3072 sc1
    s_add_u32 s10, s10, 4096
    s_add_u32 s11, s11, 4096
    s_waitcnt vmcnt(6)
    v_mfma_f32_32x32x16_bf16 v[16:31], v[128:131], v[208:211], v[16:31]
    v_mfma_f32_32x32x16_bf16 v[32:47], v[128:131], v[212:215], v[32:47]
    v_mfma_f32_32x32x16_bf16 v[48:63], v[132:135], v[208:211], v[48:63]
    v_mfma_f32_32x32x16_bf16 v[64:79], v[132:135], v[212:215], v[64:79]
    buffer_load_dwordx4 v[208:211], v3, s[40:43], s10 offen offset:0 sc1
    buffer_load_dwordx4 v[212:215], v3, s[40:43], s11 offen offset:0 sc1
    s_waitcnt vmcnt(6)
    v_mfma_f32_32x32x16_bf16 v[16:31], v[136:139], v[216:219], v[16:31]
    v_mfma_f32_32x32x16_bf16 v[32:47], v[136:139], v[220:223], v[32:47]
    v_mfma_f32_32x32x16_bf16 v[48:63], v[140:143], v[216:219], v[48:63]
    v_mfma_f32_32x32x16_bf16 v[64:79], v[140:143], v[220:223], v[64:79]
    buffer_load_dwordx4 v[216:219], v3, s[40:43], s10 offen offset:1024 sc1
    buffer_load_dwordx4 v[220:223], v3, s[40:43], s11 offen offset:1024 sc1
    s_waitcnt vmcnt(6)
    v_mfma_f32_32x32x16_bf16 v[16:31], v[144:147], v[224:227], v[16:31]
    v_mfma_f32_32x32x16_bf16 v[32:47], v[144:147], v[228:231], v[32:47]
    v_mfma_f32_32x32x16_bf16 v[48:63], v[148:151], v[224:227], v[48:63]
    v_mfma_f32_32x32x16_bf16 v[64:79], v[148:151], v[228:231], v[64:79]
    buffer_load_dwordx4 v[224:227], v3, s[40:43], s10 offen offset:2048 sc1
    buffer_load_dwordx4 v[228:231], v3, s[40:43], s11 offen offset:2048 sc1
    s_waitcnt vmcnt(6)
    v_mfma_f32_32x32x16_bf16 v[16:31], v[152:155], v[232:235], v[16:31]
    v_mfma_f32_32x32x16_bf16 v[32:47], v[152:155], v[236:239], v[32:47]
    v_mfma_f32_32x32x16_bf16 v[48:63], v[156:159], v[232:235], v[48:63]
    v_mfma_f32_32x32x16_bf16 v[64:79], v[156:159], v[236:239], v[64:79]
    buffer_load_dwordx4 v[232:235], v3, s[40:43], s10 offen offset:3072 sc1
    buffer_load_dwordx4 v[236:239], v3, s[40:43], s11 offen offset:3072 sc1
    s_add_u32 s10, s10, 4096
    s_add_u32 s11, s11, 4096
    s_waitcnt vmcnt(6)
    v_mfma_f32_32x32x16_bf16 v[16:31], v[160:163], v[208:211], v[16:31]
    v_mfma_f32_32x32x16_bf16 v[32:47], v[160:163], v[212:215], v[32:47]
    v_mfma_f32_32x32x16_bf16 v[48:63], v[164:167], v[208:211], v[48:63]
    v_mfma_f32_32x32x16_bf16 v[64:79], v[164:167], v[212:215], v[64:79]
    buffer_load_dwordx4 v[208:211], v3, s[40:43], s10 offen offset:0 sc1
    buffer_load_dwordx4 v[212:215], v3, s[40:43], s11 offen offset:0 sc1
    s_waitcnt vmcnt(6)
    v_mfma_f32_32x32x16_bf16 v[16:31], v[168:171], v[216:219], v[16:31]
    v_mfma_f32_32x32x16_bf16 v[32:47], v[168:171], v[220:223], v[32:47]
    v_mfma_f32_32x32x16_bf16 v[48:63], v[172:175], v[216:219], v[48:63]
    v_mfma_f32_32x32x16_bf16 v[64:79], v[172:175], v[220:223], v[64:79]
    buffer_load_dwordx4 v[216:219], v3, s[40:43], s10 offen offset:1024 sc1
    buffer_load_dwordx4 v[220:223], v3, s[40:43], s11 offen offset:1024 sc1
    s_waitcnt vmcnt(6)
    v_mfma_f32_32x32x16_bf16 v[16:31], v[176:179], v[224:227], v[16:31]
    v_mfma_f32_32x32x16_bf16 v[32:47], v[176:179], v[228:231], v[32:47]
    v_mfma_f32_32x32x16_bf16 v[48:63], v[180:183], v[224:227], v[48:63]
    v_mfma_f32_32x32x16_bf16 v[64:79], v[180:183], v[228:231], v[64:79]
    s_waitcnt vmcnt(4)
    v_mfma_f32_32x32x16_bf16 v[16:31], v[184:187], v[232:235], v[16:31]
    v_mfma_f32_32x32x16_bf16 v[32:47], v[184:187], v[236:239], v[32:47]
    v_mfma_f32_32x32x16_bf16 v[48:63], v[188:191], v[232:235], v[48:63]
    v_mfma_f32_32x32x16_bf16 v[64:79], v[188:191], v[236:239], v[64:79]
    s_waitcnt vmcnt(2)
    v_mfma_f32_32x32x16_bf16 v[16:31], v[192:195], v[208:211], v[16:31]
    v_mfma_f32_32x32x16_bf16 v[32:47], v[192:195], v[212:215], v[32:47]
    v_mfma_f32_32x32x16_bf16 v[48:63], v[196:199], v[208:211], v[48:63]
    v_mfma_f32_32x32x16_bf16 v[64:79], v[196:199], v[212:215], v[64:79]
    s_waitcnt vmcnt(0)
    v_mfma_f32_32x32x16_bf16 v[16:31], v[200:203], v[216:219], v[16:31]
    v_mfma_f32_32x32x16_bf16 v[32:47], v[200:203], v[220:223], v[32:47]
    v_mfma_f32_32x32x16_bf16 v[48:63], v[204:207], v[216:219], v[48:63]
    v_mfma_f32_32x32x16_bf16 v[64:79], v[204:207], v[220:223], v[64:79]
    s_nop 13
    s_lshl_b32 s60, s3, 14
    v_add_u32 v0, s60, v3
    s_cmp_eq_u32 s3, 0
    s_cbranch_scc1 Lly_rw_49
    ds_write_b128 v0, v[16:19] offset:0
    ds_write_b128 v0, v[20:23] offset:1024
    s_branch Lly_rx_50
Lly_rw_49:
    v_mov_b32 v4, v16
    v_mov_b32 v5, v17
    v_mov_b32 v6, v18
    v_mov_b32 v7, v19
    v_mov_b32 v8, v20
    v_mov_b32 v9, v21
    v_mov_b32 v10, v22
    v_mov_b32 v11, v23
Lly_rx_50:
    s_cmp_lg_u32 s38, 0
    s_cbranch_scc1 Lly_gq_51
    s_add_u32 s60, s47, 0
    buffer_load_dwordx4 v[96:99], v3, s[40:43], s60 offen offset:0
Lly_gq_51:
    s_cmp_eq_u32 s3, 1
    s_cbranch_scc1 Lly_rw_52
    ds_write_b128 v0, v[24:27] offset:2048
    ds_write_b128 v0, v[28:31] offset:3072
    s_branch Lly_rx_53
Lly_rw_52:
    v_mov_b32 v4, v24
    v_mov_b32 v5, v25
    v_mov_b32 v6, v26
    v_mov_b32 v7, v27
    v_mov_b32 v8, v28
    v_mov_b32 v9, v29
    v_mov_b32 v10, v30
    v_mov_b32 v11, v31
Lly_rx_53:
    s_cmp_lg_u32 s38, 0
    s_cbranch_scc1 Lly_gq_54
    s_add_u32 s60, s47, 0
    buffer_load_dwordx4 v[100:103], v3, s[40:43], s60 offen offset:1024
Lly_gq_54:
    s_cmp_eq_u32 s3, 2
    s_cbranch_scc1 Lly_rw_55
    ds_write_b128 v0, v[32:35] offset:4096
    ds_write_b128 v0, v[36:39] offset:5120
    s_branch Lly_rx_56
Lly_rw_55:
    v_mov_b32 v4, v32
    v_mov_b32 v5, v33
    v_mov_b32 v6, v34
    v_mov_b32 v7, v35
    v_mov_b32 v8, v36
    v_mov_b32 v9, v37
    v_mov_b32 v10, v38
    v_mov_b32 v11, v39
Lly_rx_56:
    s_cmp_lg_u32 s38, 0
    s_cbranch_scc1 Lly_gq_57
    s_add_u32 s60, s47, 0
    buffer_load_dwordx4 v[104:107], v3, s[40:43], s60 offen offset:2048
Lly_gq_57:
    s_cmp_eq_u32 s3, 3
    s_cbranch_scc1 Lly_rw_58
    ds_write_b128 v0, v[40:43] offset:6144
    ds_write_b128 v0, v[44:47] offset:7168
    s_branch Lly_rx_59
Lly_rw_58:
    v_mov_b32 v4, v40
    v_mov_b32 v5, v41
    v_mov_b32 v6, v42
    v_mov_b32 v7, v43
    v_mov_b32 v8, v44
    v_mov_b32 v9, v45
    v_mov_b32 v10, v46
    v_mov_b32 v11, v47
Lly_rx_59:
    s_cmp_lg_u32 s38, 0
    s_cbranch_scc1 Lly_gq_60
    s_add_u32 s60, s47, 0
    buffer_load_dwordx4 v[108:111], v3, s[40:43], s60 offen offset:3072
Lly_gq_60:
    s_cmp_eq_u32 s3, 4
    s_cbranch_scc1 Lly_rw_61
    ds_write_b128 v0, v[48:51] offset:8192
    ds_write_b128 v0, v[52:55] offset:9216
    s_branch Lly_rx_62
Lly_rw_61:
    v_mov_b32 v4, v48
    v_mov_b32 v5, v49
    v_mov_b32 v6, v50
    v_mov_b32 v7, v51
    v_mov_b32 v8, v52
    v_mov_b32 v9, v53
    v_mov_b32 v10, v54
    v_mov_b32 v11, v55
Lly_rx_62:
    s_cmp_lg_u32 s38, 0
    s_cbranch_scc1 Lly_gq_63
    s_add_u32 s60, s47, 32768
    buffer_load_dwordx4 v[112:115], v3, s[40:43], s60 offen offset:0
Lly_gq_63:
    s_cmp_eq_u32 s3, 5
    s_cbranch_scc1 Lly_rw_64
    ds_write_b128 v0, v[56:59] offset:10240
    ds_write_b128 v0, v[60:63] offset:11264
    s_branch Lly_rx_65
Lly_rw_64:
    v_mov_b32 v4, v56
    v_mov_b32 v5, v57
    v_mov_b32 v6, v58
    v_mov_b32 v7, v59
    v_mov_b32 v8, v60
    v_mov_b32 v9, v61
    v_mov_b32 v10, v62
    v_mov_b32 v11, v63
Lly_rx_65:
    s_cmp_lg_u32 s38, 0
    s_cbranch_scc1 Lly_gq_66
    s_add_u32 s60, s47, 32768
    buffer_load_dwordx4 v[116:119], v3, s[40:43], s60 offen offset:1024
Lly_gq_66:
    s_cmp_eq_u32 s3, 6
    s_cbranch_scc1 Lly_rw_67
    ds_write_b128 v0, v[64:67] offset:12288
    ds_write_b128 v0, v[68:71] offset:13312
    s_branch Lly_rx_68
Lly_rw_67:
    v_mov_b32 v4, v64
    v_mov_b32 v5, v65
    v_mov_b32 v6, v66
    v_mov_b32 v7, v67
    v_mov_b32 v8, v68
    v_mov_b32 v9, v69
    v_mov_b32 v10, v70
    v_mov_b32 v11, v71
Lly_rx_68:
    s_cmp_lg_u32 s38, 0
    s_cbranch_scc1 Lly_gq_69
    s_add_u32 s60, s47, 32768
    buffer_load_dwordx4 v[120:123], v3, s[40:43], s60 offen offset:2048
Lly_gq_69:
    s_cmp_eq_u32 s3, 7
    s_cbranch_scc1 Lly_rw_70
    ds_write_b128 v0, v[72:75] offset:14336
    ds_write_b128 v0, v[76:79] offset:15360
    s_branch Lly_rx_71
Lly_rw_70:
    v_mov_b32 v4, v72
    v_mov_b32 v5, v73
    v_mov_b32 v6, v74
    v_mov_b32 v7, v75
    v_mov_b32 v8, v76
    v_mov_b32 v9, v77
    v_mov_b32 v10, v78
    v_mov_b32 v11, v79
Lly_rx_71:
    s_cmp_lg_u32 s38, 0
    s_cbranch_scc1 Lly_gq_72
    s_add_u32 s60, s47, 32768
    buffer_load_dwordx4 v[124:127], v3, s[40:43], s60 offen offset:3072
Lly_gq_72:
    s_waitcnt lgkmcnt(0)
    s_barrier
    s_lshl_b32 s60, s3, 11
    v_add_u32 v0, s60, v3
    s_add_u32 s61, s3, 1
    s_and_b32 s61, s61, 7
    s_lshl_b32 s61, s61, 14
    v_add_u32 v2, s61, v0
    ds_read_b128 v[16:19], v2 offset:0
    ds_read_b128 v[20:23], v2 offset:1024
    s_add_u32 s61, s3, 2
    s_and_b32 s61, s61, 7
    s_lshl_b32 s61, s61, 14
    v_add_u32 v2, s61, v0
    ds_read_b128 v[24:27], v2 offset:0
    ds_read_b128 v[28:31], v2 offset:1024
    s_add_u32 s61, s3, 3
    s_and_b32 s61, s61, 7
    s_lshl_b32 s61, s61, 14
    v_add_u32 v2, s61, v0
    ds_read_b128 v[32:35], v2 offset:0
    ds_read_b128 v[36:39], v2 offset:1024
    s_add_u32 s61, s3, 4
    s_and_b32 s61, s61, 7
    s_lshl_b32 s61, s61, 14
    v_add_u32 v2, s61, v0
    ds_read_b128 v[40:43], v2 offset:0
    ds_read_b128 v[44:47], v2 offset:1024
    s_add_u32 s61, s3, 5
    s_and_b32 s61, s61, 7
    s_lshl_b32 s61, s61, 14
    v_add_u32 v2, s61, v0
    ds_read_b128 v[48:51], v2 offset:0
    ds_read_b128 v[52:55], v2 offset:1024
    s_add_u32 s61, s3, 6
    s_and_b32 s61, s61, 7
    s_lshl_b32 s61, s61, 14
    v_add_u32 v2, s61, v0
    ds_read_b128 v[56:59], v2 offset:0
    ds_read_b128 v[60:63], v2 offset:1024
    s_add_u32 s61, s3, 7
    s_and_b32 s61, s61, 7
    s_lshl_b32 s61, s61, 14
    v_add_u32 v2, s61, v0
    ds_read_b128 v[64:67], v2 offset:0
    ds_read_b128 v[68:71], v2 offset:1024
    s_cmp_lg_u32 s38, 0
    s_cbranch_scc1 Lly_gq_73
    s_lshl_b32 s60, s3, 12
    s_add_u32 s60, s60, 34406400
    buffer_load_dwordx4 v[128:131], v3, s[40:43], s60 offen offset:0
Lly_gq_73:
    s_cmp_lg_u32 s38, 0
    s_cbranch_scc1 Lly_gq_74
    s_lshl_b32 s60, s3, 12
    s_add_u32 s60, s60, 34406400
    buffer_load_dwordx4 v[132:135], v3, s[40:43], s60 offen offset:1024
Lly_gq_74:
    s_cmp_lg_u32 s38, 0
    s_cbranch_scc1 Lly_gq_75
    s_lshl_b32 s60, s3, 12
    s_add_u32 s60, s60, 34406400
    buffer_load_dwordx4 v[136:139], v3, s[40:43], s60 offen offset:2048
Lly_gq_75:
    s_cmp_lg_u32 s38, 0
    s_cbranch_scc1 Lly_gq_76
    s_lshl_b32 s60, s3, 12
    s_add_u32 s60, s60, 34406400
    buffer_load_dwordx4 v[140:143], v3, s[40:43], s60 offen offset:3072
Lly_gq_76:
    s_waitcnt lgkmcnt(12)
    v_add_f32 v4, v4, v16
    v_add_f32 v5, v5, v17
    v_add_f32 v6, v6, v18
    v_add_f32 v7, v7, v19
    v_add_f32 v8, v8, v20
    v_add_f32 v9, v9, v21
    v_add_f32 v10, v10, v22
    v_add_f32 v11, v11, v23
    s_waitcnt lgkmcnt(10)
    v_add_f32 v4, v4, v24
    v_add_f32 v5, v5, v25
    v_add_f32 v6, v6, v26
    v_add_f32 v7, v7, v27
    v_add_f32 v8, v8, v28
    v_add_f32 v9, v9, v29
    v_add_f32 v10, v10, v30
    v_add_f32 v11, v11, v31
    s_waitcnt lgkmcnt(8)
    v_add_f32 v4, v4, v32
    v_add_f32 v5, v5, v33
    v_add_f32 v6, v6, v34
    v_add_f32 v7, v7, v35
    v_add_f32 v8, v8, v36
    v_add_f32 v9, v9, v37
    v_add_f32 v10, v10, v38
    v_add_f32 v11, v11, v39
    s_waitcnt lgkmcnt(6)
    v_add_f32 v4, v4, v40
    v_add_f32 v5, v5, v41
    v_add_f32 v6, v6, v42
    v_add_f32 v7, v7, v43
    v_add_f32 v8, v8, v44
    v_add_f32 v9, v9, v45
    v_add_f32 v10, v10, v46
    v_add_f32 v11, v11, v47
    s_waitcnt lgkmcnt(4)
    v_add_f32 v4, v4, v48
    v_add_f32 v5, v5, v49
    v_add_f32 v6, v6, v50
    v_add_f32 v7, v7, v51
    v_add_f32 v8, v8, v52
    v_add_f32 v9, v9, v53
    v_add_f32 v10, v10, v54
    v_add_f32 v11, v11, v55
    s_waitcnt lgkmcnt(2)
    v_add_f32 v4, v4, v56
    v_add_f32 v5, v5, v57
    v_add_f32 v6, v6, v58
    v_add_f32 v7, v7, v59
    v_add_f32 v8, v8, v60
    v_add_f32 v9, v9, v61
    v_add_f32 v10, v10, v62
    v_add_f32 v11, v11, v63
    s_waitcnt lgkmcnt(0)
    v_add_f32 v4, v4, v64
    v_add_f32 v5, v5, v65
    v_add_f32 v6, v6, v66
    v_add_f32 v7, v7, v67
    v_add_f32 v8, v8, v68
    v_add_f32 v9, v9, v69
    v_add_f32 v10, v10, v70
    v_add_f32 v11, v11, v71
    v_cvt_pk_bf16_f32 v16, v4, v5
    v_cvt_pk_bf16_f32 v17, v6, v7
    v_cvt_pk_bf16_f32 v18, v8, v9
    v_cvt_pk_bf16_f32 v19, v10, v11
    v_lshlrev_b32 v4, 16, v16
    v_and_b32 v5, 0xffff0000, v16
    v_lshlrev_b32 v24, 16, v12
    v_and_b32 v25, 0xffff0000, v12
    v_add_f32 v4, v4, v24
    v_add_f32 v5, v5, v25
    v_lshlrev_b32 v6, 16, v17
    v_and_b32 v7, 0xffff0000, v17
    v_lshlrev_b32 v24, 16, v13
    v_and_b32 v25, 0xffff0000, v13
    v_add_f32 v6, v6, v24
    v_add_f32 v7, v7, v25
    v_lshlrev_b32 v8, 16, v18
    v_and_b32 v9, 0xffff0000, v18
    v_lshlrev_b32 v24, 16, v14
    v_and_b32 v25, 0xffff0000, v14
    v_add_f32 v8, v8, v24
    v_add_f32 v9, v9, v25
    v_lshlrev_b32 v10, 16, v19
    v_and_b32 v11, 0xffff0000, v19
    v_lshlrev_b32 v24, 16, v15
    v_and_b32 v25, 0xffff0000, v15
    v_add_f32 v10, v10, v24
    v_add_f32 v11, v11, v25
    v_cvt_pk_bf16_f32 v16, v4, v5
    v_cvt_pk_bf16_f32 v17, v6, v7
    v_cvt_pk_bf16_f32 v18, v8, v9
    v_cvt_pk_bf16_f32 v19, v10, v11
    s_cmp_lg_u32 s38, 0
    s_cbranch_scc1 Lly_fin_77
    v_lshlrev_b32 v4, 16, v16
    v_and_b32 v5, 0xffff0000, v16
    v_lshlrev_b32 v6, 16, v17
    v_and_b32 v7, 0xffff0000, v17
    v_lshlrev_b32 v8, 16, v18
    v_and_b32 v9, 0xffff0000, v18
    v_lshlrev_b32 v10, 16, v19
    v_and_b32 v11, 0xffff0000, v19
    v_add_f32 v24, v4, v5
    v_mul_f32 v25, v4, v4
    v_fmac_f32 v25, v5, v5
    v_add_f32 v24, v24, v6
    v_fmac_f32 v25, v6, v6
    v_add_f32 v24, v24, v7
    v_fmac_f32 v25, v7, v7
    v_add_f32 v24, v24, v8
    v_fmac_f32 v25, v8, v8
    v_add_f32 v24, v24, v9
    v_fmac_f32 v25, v9, v9
    v_add_f32 v24, v24, v10
    v_fmac_f32 v25, v10, v10
    v_add_f32 v24, v24, v11
    v_fmac_f32 v25, v11, v11
    v_mov_b32 v26, v24
    v_mov_b32 v27, v25
    v_and_b32 v0, 31, v1
    v_lshlrev_b32 v0, 3, v0
    v_permlane32_swap_b32 v24, v26
    v_permlane32_swap_b32 v25, v27
    s_lshl_b32 s60, s56, 5
    s_add_u32 s60, s60, s57
    s_lshl_b32 s60, s60, 8
    s_add_u32 s60, s60, 33357824
    v_add_f32 v24, v24, v26
    v_add_f32 v25, v25, v27
    s_cmp_eq_u32 s52, 1
    s_cbranch_scc1 Lly_hs_79
    buffer_store_dwordx4 v[16:19], v3, s[40:43], s59 offen sc1
    buffer_store_dwordx2 v[24:25], v0, s[40:43], s60 offen sc1
    s_branch Lly_he_80
Lly_hs_79:
    buffer_store_dwordx4 v[16:19], v3, s[40:43], s59 offen
    buffer_store_dwordx2 v[24:25], v0, s[40:43], s60 offen
Lly_he_80:
    s_branch Lly_fie_78
Lly_fin_77:
    s_mov_b32 s64, s32
    s_and_b32 s65, s33, 0xffff
    s_mov_b32 s66, 2097152
    s_mov_b32 s67, 0x00020000
    v_and_b32 v0, 31, v1
    v_lshlrev_b32 v0, 10, v0
    v_lshrrev_b32 v2, 5, v1
    v_lshl_add_u32 v0, v2, 3, v0
    s_lshl_b32 s60, s56, 15
    s_lshl_b32 s61, s57, 5
    s_add_u32 s60, s60, s61
    buffer_store_dwordx2 v[16:17], v0, s[64:67], s60 offen
    buffer_store_dwordx2 v[18:19], v0, s[64:67], s60 offen offset:16
Lly_fie_78:
    s_cmp_lg_u32 s38, 0
    s_cbranch_scc1 Lly_noq_81
    s_waitcnt vmcnt(0)
    s_barrier
    s_cmp_lg_u32 s3, 7
    s_cbranch_scc1 Lly_sig_82
    s_lshl_b32 s60, s5, 7
    s_lshl_b32 s61, s6, 2
    s_add_u32 s60, s60, s61
    s_add_u32 s60, s60, 12288
    v_mov_b32 v4, 1
    v_mov_b32 v5, 0
    s_mov_b64 exec, 1
    s_cmp_eq_u32 s52, 1
    s_cbranch_scc1 Lly_hs_83
    buffer_store_dword v4, v5, s[40:43], s60 offen sc1
    s_branch Lly_he_84
Lly_hs_83:
    buffer_store_dword v4, v5, s[40:43], s60 offen
Lly_he_84:
    s_mov_b64 exec, -1
Lly_sig_82:
    s_lshl_b32 s60, s5, 7
    s_lshl_b32 s61, s3, 2
    s_add_u32 s60, s60, s61
    s_add_u32 s60, s60, 12288
    v_mov_b32 v5, 0
    s_mov_b32 s61, 0
    s_mov_b64 exec, 1
Lly_wp_85:
    buffer_load_dword v4, v5, s[40:43], s60 offen sc1
    s_waitcnt vmcnt(0)
    v_readfirstlane_b32 s62, v4
    s_cmp_eq_u32 s62, 1
    s_cbranch_scc1 Lly_wd_86
    s_add_u32 s61, s61, 1
    s_cmp_ge_u32 s61, 0x400000
    s_cbranch_scc1 Lly_wd_86
    s_sleep 1
    s_branch Lly_wp_85
Lly_wd_86:
    s_mov_b64 exec, -1
    s_lshr_b32 s60, s3, 1
    s_and_b32 s56, s60, 1
    s_lshl_b32 s61, s5, 1
    s_add_u32 s56, s56, s61
    s_lshr_b32 s57, s3, 2
    s_lshl_b32 s61, s6, 1
    s_add_u32 s57, s57, s61
    s_lshl_b32 s57, s57, 1
    s_and_b32 s61, s3, 1
    s_add_u32 s57, s57, s61
    s_lshl_b32 s58, s56, 5
    s_add_u32 s58, s58, s57
    s_lshl_b32 s58, s58, 10
    s_add_u32 s58, s58, 21299200
    s_lshl_b32 s8, s5, 16
    s_lshl_b32 s9, s3, 12
    s_add_u32 s8, s8, s9
    s_add_u32 s8, s8, 17104896
    s_add_u32 s9, s8, 32768
    buffer_load_dwordx4 v[208:211], v3, s[40:43], s8 offen offset:0 sc1
    buffer_load_dwordx4 v[212:215], v3, s[40:43], s9 offen offset:0 sc1
    buffer_load_dwordx4 v[216:219], v3, s[40:43], s8 offen offset:1024 sc1
    buffer_load_dwordx4 v[220:223], v3, s[40:43], s9 offen offset:1024 sc1
    buffer_load_dwordx4 v[224:227], v3, s[40:43], s8 offen offset:2048 sc1
    buffer_load_dwordx4 v[228:231], v3, s[40:43], s9 offen offset:2048 sc1
    buffer_load_dwordx4 v[232:235], v3, s[40:43], s8 offen offset:3072 sc1
    buffer_load_dwordx4 v[236:239], v3, s[40:43], s9 offen offset:3072 sc1
    v_and_b32 v6, 31, v1
    v_lshlrev_b32 v6, 3, v6
    v_lshrrev_b32 v7, 5, v1
    v_lshl_add_u32 v6, v7, 9, v6
    s_lshl_b32 s60, s5, 14
    s_lshl_b32 s61, s3, 10
    s_add_u32 s60, s60, s61
    s_add_u32 s60, s60, 33357824
    s_add_u32 s61, s60, 8192
    buffer_load_dwordx2 v[8:9], v6, s[40:43], s60 offen sc1
    buffer_load_dwordx2 v[200:201], v6, s[40:43], s60 offen offset:256 sc1
    buffer_load_dwordx2 v[10:11], v6, s[40:43], s61 offen sc1
    buffer_load_dwordx2 v[202:203], v6, s[40:43], s61 offen offset:256 sc1
    v_lshrrev_b32 v4, 5, v1
    v_lshlrev_b32 v4, 4, v4
    s_lshl_b32 s60, s57, 6
    s_add_u32 s60, s60, 38633472
    buffer_load_dwordx4 v[240:243], v4, s[40:43], s60 offen
    buffer_load_dwordx4 v[244:247], v4, s[40:43], s60 offen offset:32
    buffer_load_dwordx4 v[192:195], v4, s[40:43], s60 offen offset:2048
    buffer_load_dwordx4 v[196:199], v4, s[40:43], s60 offen offset:2080
    s_mov_b32 s60, 38637568
    buffer_load_dwordx4 v[248:251], v4, s[40:43], s60 offen
    buffer_load_dwordx4 v[252:255], v4, s[40:43], s60 offen offset:32
    v_and_b32 v5, 31, v1
    v_lshlrev_b32 v5, 2, v5
    buffer_load_dword v15, v5, s[40:43], s60 offen
    s_waitcnt vmcnt(17)
    v_mfma_f32_32x32x16_bf16 v[16:31], v[96:99], v[208:211], 0
    v_mfma_f32_32x32x16_bf16 v[32:47], v[96:99], v[212:215], 0
    v_mfma_f32_32x32x16_bf16 v[48:63], v[112:115], v[208:211], 0
    v_mfma_f32_32x32x16_bf16 v[64:79], v[112:115], v[212:215], 0
    s_waitcnt vmcnt(15)
    v_mfma_f32_32x32x16_bf16 v[16:31], v[100:103], v[216:219], v[16:31]
    v_mfma_f32_32x32x16_bf16 v[32:47], v[100:103], v[220:223], v[32:47]
    v_mfma_f32_32x32x16_bf16 v[48:63], v[116:119], v[216:219], v[48:63]
    v_mfma_f32_32x32x16_bf16 v[64:79], v[116:119], v[220:223], v[64:79]
    s_waitcnt vmcnt(13)
    v_mfma_f32_32x32x16_bf16 v[16:31], v[104:107], v[224:227], v[16:31]
    v_mfma_f32_32x32x16_bf16 v[32:47], v[104:107], v[228:231], v[32:47]
    v_mfma_f32_32x32x16_bf16 v[48:63], v[120:123], v[224:227], v[48:63]
    v_mfma_f32_32x32x16_bf16 v[64:79], v[120:123], v[228:231], v[64:79]
    s_waitcnt vmcnt(11)
    v_mfma_f32_32x32x16_bf16 v[16:31], v[108:111], v[232:235], v[16:31]
    v_mfma_f32_32x32x16_bf16 v[32:47], v[108:111], v[236:239], v[32:47]
    v_mfma_f32_32x32x16_bf16 v[48:63], v[124:127], v[232:235], v[48:63]
    v_mfma_f32_32x32x16_bf16 v[64:79], v[124:127], v[236:239], v[64:79]
    s_cmp_ge_u32 s6, 4
    s_cbranch_scc1 Lly_kve_87
    s_cmp_lg_u32 s6, 0
    s_cbranch_scc1 Lly_kvn_88
    v_mfma_f32_32x32x16_bf16 v[80:95], v[128:131], v[208:211], 0
    v_mfma_f32_32x32x16_bf16 v[80:95], v[132:135], v[216:219], v[80:95]
    v_mfma_f32_32x32x16_bf16 v[80:95], v[136:139], v[224:227], v[80:95]
    v_mfma_f32_32x32x16_bf16 v[80:95], v[140:143], v[232:235], v[80:95]
    s_branch Lly_kve_87
Lly_kvn_88:
    s_cmp_lg_u32 s6, 1
    s_cbranch_scc1 Lly_kvn_89
    v_mfma_f32_32x32x16_bf16 v[80:95], v[128:131], v[212:215], 0
    v_mfma_f32_32x32x16_bf16 v[80:95], v[132:135], v[220:223], v[80:95]
    v_mfma_f32_32x32x16_bf16 v[80:95], v[136:139], v[228:231], v[80:95]
    v_mfma_f32_32x32x16_bf16 v[80:95], v[140:143], v[236:239], v[80:95]
    s_branch Lly_kve_87
Lly_kvn_89:
    s_cmp_lg_u32 s6, 2
    s_cbranch_scc1 Lly_kvn_90
    v_mfma_f32_32x32x16_bf16 v[80:95], v[208:211], v[128:131], 0
    v_mfma_f32_32x32x16_bf16 v[80:95], v[216:219], v[132:135], v[80:95]
    v_mfma_f32_32x32x16_bf16 v[80:95], v[224:227], v[136:139], v[80:95]
    v_mfma_f32_32x32x16_bf16 v[80:95], v[232:235], v[140:143], v[80:95]
    s_branch Lly_kve_87
Lly_kvn_90:
    s_cmp_lg_u32 s6, 3
    s_cbranch_scc1 Lly_kvn_91
    v_mfma_f32_32x32x16_bf16 v[80:95], v[212:215], v[128:131], 0
    v_mfma_f32_32x32x16_bf16 v[80:95], v[220:223], v[132:135], v[80:95]
    v_mfma_f32_32x32x16_bf16 v[80:95], v[228:231], v[136:139], v[80:95]
    v_mfma_f32_32x32x16_bf16 v[80:95], v[236:239], v[140:143], v[80:95]
    s_branch Lly_kve_87
Lly_kvn_91:
Lly_kve_87:
    s_waitcnt vmcnt(7)
    v_add_f32 v8, v8, v200
    v_add_f32 v9, v9, v201
    v_add_f32 v10, v10, v202
    v_add_f32 v11, v11, v203
    v_mov_b32 v4, v8
    v_mov_b32 v5, v9
    v_mov_b32 v6, v10
    v_mov_b32 v7, v11
    s_lshl_b32 s60, s3, 9
    v_and_b32 v14, 31, v1
    v_permlane32_swap_b32 v8, v4
    v_permlane32_swap_b32 v9, v5
    v_permlane32_swap_b32 v10, v6
    v_permlane32_swap_b32 v11, v7
    v_lshlrev_b32 v14, 4, v14
    v_add_u32 v14, 135168, v14
    v_add_f32 v8, v8, v4
    v_add_f32 v9, v9, v5
    v_add_f32 v10, v10, v6
    v_add_f32 v11, v11, v7
    v_add_u32 v4, s60, v14
    s_nop 5
    ds_write_b128 v4, v[8:11]
    s_lshl_b32 s60, s3, 14
    v_add_u32 v0, s60, v3
    s_cmp_eq_u32 s3, 0
    s_cbranch_scc1 Lly_rw_92
    ds_write_b128 v0, v[16:19] offset:0
    ds_write_b128 v0, v[20:23] offset:1024
    s_branch Lly_rx_93
Lly_rw_92:
    v_mov_b32 v4, v16
    v_mov_b32 v5, v17
    v_mov_b32 v6, v18
    v_mov_b32 v7, v19
    v_mov_b32 v8, v20
    v_mov_b32 v9, v21
    v_mov_b32 v10, v22
    v_mov_b32 v11, v23
Lly_rx_93:
    s_cmp_eq_u32 s3, 1
    s_cbranch_scc1 Lly_rw_94
    ds_write_b128 v0, v[24:27] offset:2048
    ds_write_b128 v0, v[28:31] offset:3072
    s_branch Lly_rx_95
Lly_rw_94:
    v_mov_b32 v4, v24
    v_mov_b32 v5, v25
    v_mov_b32 v6, v26
    v_mov_b32 v7, v27
    v_mov_b32 v8, v28
    v_mov_b32 v9, v29
    v_mov_b32 v10, v30
    v_mov_b32 v11, v31
Lly_rx_95:
    s_cmp_eq_u32 s3, 2
    s_cbranch_scc1 Lly_rw_96
    ds_write_b128 v0, v[32:35] offset:4096
    ds_write_b128 v0, v[36:39] offset:5120
    s_branch Lly_rx_97
Lly_rw_96:
    v_mov_b32 v4, v32
    v_mov_b32 v5, v33
    v_mov_b32 v6, v34
    v_mov_b32 v7, v35
    v_mov_b32 v8, v36
    v_mov_b32 v9, v37
    v_mov_b32 v10, v38
    v_mov_b32 v11, v39
Lly_rx_97:
    s_cmp_eq_u32 s3, 3
    s_cbranch_scc1 Lly_rw_98
    ds_write_b128 v0, v[40:43] offset:6144
    ds_write_b128 v0, v[44:47] offset:7168
    s_branch Lly_rx_99
Lly_rw_98:
    v_mov_b32 v4, v40
    v_mov_b32 v5, v41
    v_mov_b32 v6, v42
    v_mov_b32 v7, v43
    v_mov_b32 v8, v44
    v_mov_b32 v9, v45
    v_mov_b32 v10, v46
    v_mov_b32 v11, v47
Lly_rx_99:
    s_cmp_eq_u32 s3, 4
    s_cbranch_scc1 Lly_rw_100
    ds_write_b128 v0, v[48:51] offset:8192
    ds_write_b128 v0, v[52:55] offset:9216
    s_branch Lly_rx_101
Lly_rw_100:
    v_mov_b32 v4, v48
    v_mov_b32 v5, v49
    v_mov_b32 v6, v50
    v_mov_b32 v7, v51
    v_mov_b32 v8, v52
    v_mov_b32 v9, v53
    v_mov_b32 v10, v54
    v_mov_b32 v11, v55
Lly_rx_101:
    s_cmp_eq_u32 s3, 5
    s_cbranch_scc1 Lly_rw_102
    ds_write_b128 v0, v[56:59] offset:10240
    ds_write_b128 v0, v[60:63] offset:11264
    s_branch Lly_rx_103
Lly_rw_102:
    v_mov_b32 v4, v56
    v_mov_b32 v5, v57
    v_mov_b32 v6, v58
    v_mov_b32 v7, v59
    v_mov_b32 v8, v60
    v_mov_b32 v9, v61
    v_mov_b32 v10, v62
    v_mov_b32 v11, v63
Lly_rx_103:
    s_cmp_eq_u32 s3, 6
    s_cbranch_scc1 Lly_rw_104
    ds_write_b128 v0, v[64:67] offset:12288
    ds_write_b128 v0, v[68:71] offset:13312
    s_branch Lly_rx_105
Lly_rw_104:
    v_mov_b32 v4, v64
    v_mov_b32 v5, v65
    v_mov_b32 v6, v66
    v_mov_b32 v7, v67
    v_mov_b32 v8, v68
    v_mov_b32 v9, v69
    v_mov_b32 v10, v70
    v_mov_b32 v11, v71
Lly_rx_105:
    s_cmp_eq_u32 s3, 7
    s_cbranch_scc1 Lly_rw_106
    ds_write_b128 v0, v[72:75] offset:14336
    ds_write_b128 v0, v[76:79] offset:15360
    s_branch Lly_rx_107
Lly_rw_106:
    v_mov_b32 v4, v72
    v_mov_b32 v5, v73
    v_mov_b32 v6, v74
    v_mov_b32 v7, v75
    v_mov_b32 v8, v76
    v_mov_b32 v9, v77
    v_mov_b32 v10, v78
    v_mov_b32 v11, v79
Lly_rx_107:
    s_cmp_ge_u32 s6, 4
    s_cbranch_scc1 Lly_kvw_108
    s_mul_i32 s60, s3, 18432
    v_add_u32 v2, s60, v3
    ds_write_b128 v2, v[80:83] offset:0
    ds_write_b128 v2, v[84:87] offset:1024
    s_cmp_lt_u32 s6, 2
    s_cbranch_scc1 Lly_kvw_108
    s_lshl_b32 s60, s3, 11
    v_add_u32 v2, s60, v3
    v_add_u32 v2, 143360, v2
    ds_write_b128 v2, v[88:91]
    ds_write_b128 v2, v[92:95] offset:1024
Lly_kvw_108:
    s_waitcnt lgkmcnt(0)
    s_barrier
    ds_read_b128 v[208:211], v14 offset:0
    ds_read_b128 v[212:215], v14 offset:512
    ds_read_b128 v[216:219], v14 offset:1024
    ds_read_b128 v[220:223], v14 offset:1536
    ds_read_b128 v[224:227], v14 offset:2048
    ds_read_b128 v[228:231], v14 offset:2560
    ds_read_b128 v[232:235], v14 offset:3072
    ds_read_b128 v[236:239], v14 offset:3584
    s_waitcnt lgkmcnt(0)
    s_lshl_b32 s60, s3, 11
    v_add_u32 v0, s60, v3
    s_add_u32 s61, s3, 1
    s_and_b32 s61, s61, 7
    s_lshl_b32 s61, s61, 14
    v_add_u32 v2, s61, v0
    ds_read_b128 v[16:19], v2 offset:0
    ds_read_b128 v[20:23], v2 offset:1024
    s_add_u32 s61, s3, 2
    s_and_b32 s61, s61, 7
    s_lshl_b32 s61, s61, 14
    v_add_u32 v2, s61, v0
    ds_read_b128 v[24:27], v2 offset:0
    ds_read_b128 v[28:31], v2 offset:1024
    s_add_u32 s61, s3, 3
    s_and_b32 s61, s61, 7
    s_lshl_b32 s61, s61, 14
    v_add_u32 v2, s61, v0
    ds_read_b128 v[32:35], v2 offset:0
    ds_read_b128 v[36:39], v2 offset:1024
    s_add_u32 s61, s3, 4
    s_and_b32 s61, s61, 7
    s_lshl_b32 s61, s61, 14
    v_add_u32 v2, s61, v0
    ds_read_b128 v[40:43], v2 offset:0
    ds_read_b128 v[44:47], v2 offset:1024
    s_add_u32 s61, s3, 5
    s_and_b32 s61, s61, 7
    s_lshl_b32 s61, s61, 14
    v_add_u32 v2, s61, v0
    ds_read_b128 v[48:51], v2 offset:0
    ds_read_b128 v[52:55], v2 offset:1024
    s_add_u32 s61, s3, 6
    s_and_b32 s61, s61, 7
    s_lshl_b32 s61, s61, 14
    v_add_u32 v2, s61, v0
    ds_read_b128 v[56:59], v2 offset:0
    ds_read_b128 v[60:63], v2 offset:1024
    s_add_u32 s61, s3, 7
    s_and_b32 s61, s61, 7
    s_lshl_b32 s61, s61, 14
    v_add_u32 v2, s61, v0
    ds_read_b128 v[64:67], v2 offset:0
    ds_read_b128 v[68:71], v2 offset:1024
    v_add_f32 v208, v208, v212
    v_add_f32 v209, v209, v213
    v_add_f32 v210, v210, v214
    v_add_f32 v211, v211, v215
    v_add_f32 v208, v208, v216
    v_add_f32 v209, v209, v217
    v_add_f32 v210, v210, v218
    v_add_f32 v211, v211, v219
    v_add_f32 v208, v208, v220
    v_add_f32 v209, v209, v221
    v_add_f32 v210, v210, v222
    v_add_f32 v211, v211, v223
    v_add_f32 v208, v208, v224
    v_add_f32 v209, v209, v225
    v_add_f32 v210, v210, v226
    v_add_f32 v211, v211, v227
    v_add_f32 v208, v208, v228
    v_add_f32 v209, v209, v229
    v_add_f32 v210, v210, v230
    v_add_f32 v211, v211, v231
    v_add_f32 v208, v208, v232
    v_add_f32 v209, v209, v233
    v_add_f32 v210, v210, v234
    v_add_f32 v211, v211, v235
    v_add_f32 v208, v208, v236
    v_add_f32 v209, v209, v237
    v_add_f32 v210, v210, v238
    v_add_f32 v211, v211, v239
    v_mul_f32 v12, 0x3b000000, v208
    v_mul_f32 v13, 0x3b000000, v209
    v_fma_f32 v13, -v12, v12, v13
    v_max_f32 v13, 0, v13
    v_cvt_pk_bf16_f32 v232, v12, v12
    v_lshlrev_b32 v232, 16, v232
    v_cvt_pk_bf16_f32 v13, v13, v13
    v_lshlrev_b32 v13, 16, v13
    v_add_f32 v13, 0x3727c5ac, v13
    v_cvt_pk_bf16_f32 v13, v13, v13
    v_lshlrev_b32 v13, 16, v13
    v_sqrt_f32 v13, v13
    s_nop 0
    v_cvt_pk_bf16_f32 v13, v13, v13
    v_lshlrev_b32 v13, 16, v13
    v_rcp_f32 v233, v13
    s_nop 0
    v_mul_f32 v12, 0x3b000000, v210
    v_mul_f32 v13, 0x3b000000, v211
    v_fma_f32 v13, -v12, v12, v13
    v_max_f32 v13, 0, v13
    v_cvt_pk_bf16_f32 v234, v12, v12
    v_lshlrev_b32 v234, 16, v234
    v_cvt_pk_bf16_f32 v13, v13, v13
    v_lshlrev_b32 v13, 16, v13
    v_add_f32 v13, 0x3727c5ac, v13
    v_cvt_pk_bf16_f32 v13, v13, v13
    v_lshlrev_b32 v13, 16, v13
    v_sqrt_f32 v13, v13
    s_nop 0
    v_cvt_pk_bf16_f32 v13, v13, v13
    v_lshlrev_b32 v13, 16, v13
    v_rcp_f32 v235, v13
    s_nop 0
    s_waitcnt lgkmcnt(12)
    v_add_f32 v4, v4, v16
    v_add_f32 v5, v5, v17
    v_add_f32 v6, v6, v18
    v_add_f32 v7, v7, v19
    v_add_f32 v8, v8, v20
    v_add_f32 v9, v9, v21
    v_add_f32 v10, v10, v22
    v_add_f32 v11, v11, v23
    s_waitcnt lgkmcnt(10)
    v_add_f32 v4, v4, v24
    v_add_f32 v5, v5, v25
    v_add_f32 v6, v6, v26
    v_add_f32 v7, v7, v27
    v_add_f32 v8, v8, v28
    v_add_f32 v9, v9, v29
    v_add_f32 v10, v10, v30
    v_add_f32 v11, v11, v31
    s_waitcnt lgkmcnt(8)
    v_add_f32 v4, v4, v32
    v_add_f32 v5, v5, v33
    v_add_f32 v6, v6, v34
    v_add_f32 v7, v7, v35
    v_add_f32 v8, v8, v36
    v_add_f32 v9, v9, v37
    v_add_f32 v10, v10, v38
    v_add_f32 v11, v11, v39
    s_waitcnt lgkmcnt(6)
    v_add_f32 v4, v4, v40
    v_add_f32 v5, v5, v41
    v_add_f32 v6, v6, v42
    v_add_f32 v7, v7, v43
    v_add_f32 v8, v8, v44
    v_add_f32 v9, v9, v45
    v_add_f32 v10, v10, v46
    v_add_f32 v11, v11, v47
    s_waitcnt lgkmcnt(4)
    v_add_f32 v4, v4, v48
    v_add_f32 v5, v5, v49
    v_add_f32 v6, v6, v50
    v_add_f32 v7, v7, v51
    v_add_f32 v8, v8, v52
    v_add_f32 v9, v9, v53
    v_add_f32 v10, v10, v54
    v_add_f32 v11, v11, v55
    s_waitcnt lgkmcnt(2)
    v_add_f32 v4, v4, v56
    v_add_f32 v5, v5, v57
    v_add_f32 v6, v6, v58
    v_add_f32 v7, v7, v59
    v_add_f32 v8, v8, v60
    v_add_f32 v9, v9, v61
    v_add_f32 v10, v10, v62
    v_add_f32 v11, v11, v63
    s_waitcnt lgkmcnt(0)
    v_add_f32 v4, v4, v64
    v_add_f32 v5, v5, v65
    v_add_f32 v6, v6, v66
    v_add_f32 v7, v7, v67
    v_add_f32 v8, v8, v68
    v_add_f32 v9, v9, v69
    v_add_f32 v10, v10, v70
    v_add_f32 v11, v11, v71
    s_mov_b32 s21, 0
    s_cmp_ge_u32 s6, 4
    s_cbranch_scc1 Lly_nk_111
    s_cmp_ge_u32 s3, 2
    s_cbranch_scc1 Lly_nk_111
    s_and_b32 s7, s6, 1
    s_lshl_b32 s8, s5, 1
    s_add_u32 s8, s8, s7
    s_cmp_eq_u32 s3, 1
    s_cselect_b32 s9, 1, 0
    s_cmp_lt_u32 s6, 2
    s_cselect_b32 s10, 1, 0
    s_and_b32 s10, s10, s9
    s_cmp_lg_u32 s10, 0
    s_cbranch_scc1 Lly_nk_111
    s_mov_b32 s21, 1
    s_cmp_eq_u32 s3, 1
    s_cbranch_scc1 Lly_ka_112
    v_add_u32 v2, 0, v3
    s_mov_b32 s11, 18432
    s_branch Lly_kb_113
Lly_ka_112:
    v_add_u32 v2, 143360, v3
    s_mov_b32 s11, 2048
Lly_kb_113:
    ds_read_b128 v[96:99], v2
    ds_read_b128 v[100:103], v2 offset:1024
    v_add_u32 v2, s11, v2
    ds_read_b128 v[104:107], v2
    ds_read_b128 v[108:111], v2 offset:1024
    v_add_u32 v2, s11, v2
    ds_read_b128 v[112:115], v2
    ds_read_b128 v[116:119], v2 offset:1024
    v_add_u32 v2, s11, v2
    ds_read_b128 v[120:123], v2
    ds_read_b128 v[124:127], v2 offset:1024
    v_add_u32 v2, s11, v2
    ds_read_b128 v[128:131], v2
    ds_read_b128 v[132:135], v2 offset:1024
    v_add_u32 v2, s11, v2
    ds_read_b128 v[136:139], v2
    ds_read_b128 v[140:143], v2 offset:1024
    v_add_u32 v2, s11, v2
    ds_read_b128 v[176:179], v2
    ds_read_b128 v[180:183], v2 offset:1024
    v_add_u32 v2, s11, v2
    s_waitcnt lgkmcnt(8)
    ds_read_b128 v[184:187], v2
    ds_read_b128 v[188:191], v2 offset:1024
    v_add_u32 v2, s11, v2
Lly_nk_111:
    v_mov_b32 v12, v232
    v_mov_b32 v13, v233
    s_bitcmp0_b32 s3, 1
    s_cbranch_scc1 Lly_qt_114
    v_mov_b32 v12, v234
    v_mov_b32 v13, v235
Lly_qt_114:
    v_mul_f32 v13, 0x3eb8aa3b, v13
    s_waitcnt vmcnt(0)
    v_add_f32 v240, v240, v192
    v_add_f32 v241, v241, v193
    v_add_f32 v242, v242, v194
    v_add_f32 v243, v243, v195
    v_add_f32 v244, v244, v196
    v_add_f32 v245, v245, v197
    v_add_f32 v246, v246, v198
    v_add_f32 v247, v247, v199
    v_fma_f32 v4, -v12, v240, v4
    v_mul_f32 v4, v13, v4
    v_fma_f32 v5, -v12, v241, v5
    v_mul_f32 v5, v13, v5
    v_fma_f32 v6, -v12, v242, v6
    v_mul_f32 v6, v13, v6
    v_fma_f32 v7, -v12, v243, v7
    v_mul_f32 v7, v13, v7
    v_fma_f32 v8, -v12, v244, v8
    v_mul_f32 v8, v13, v8
    v_fma_f32 v9, -v12, v245, v9
    v_mul_f32 v9, v13, v9
    v_fma_f32 v10, -v12, v246, v10
    v_mul_f32 v10, v13, v10
    v_fma_f32 v11, -v12, v247, v11
    v_mul_f32 v11, v13, v11
    v_cvt_pk_bf16_f32 v64, v4, v5
    v_cvt_pk_bf16_f32 v65, v6, v7
    v_cvt_pk_bf16_f32 v66, v8, v9
    v_cvt_pk_bf16_f32 v67, v10, v11
    buffer_store_dwordx4 v[64:67], v3, s[40:43], s58 offen
    s_cmp_eq_u32 s21, 0
    s_cbranch_scc1 Lly_kvfin_110
    s_waitcnt lgkmcnt(0)
    v_add_f32 v144, v96, v104
    v_add_f32 v145, v97, v105
    v_add_f32 v146, v98, v106
    v_add_f32 v147, v99, v107
    v_add_f32 v148, v100, v108
    v_add_f32 v149, v101, v109
    v_add_f32 v150, v102, v110
    v_add_f32 v151, v103, v111
    v_add_f32 v144, v144, v112
    v_add_f32 v145, v145, v113
    v_add_f32 v146, v146, v114
    v_add_f32 v147, v147, v115
    v_add_f32 v148, v148, v116
    v_add_f32 v149, v149, v117
    v_add_f32 v150, v150, v118
    v_add_f32 v151, v151, v119
    v_add_f32 v144, v144, v120
    v_add_f32 v145, v145, v121
    v_add_f32 v146, v146, v122
    v_add_f32 v147, v147, v123
    v_add_f32 v148, v148, v124
    v_add_f32 v149, v149, v125
    v_add_f32 v150, v150, v126
    v_add_f32 v151, v151, v127
    v_add_f32 v144, v144, v128
    v_add_f32 v145, v145, v129
    v_add_f32 v146, v146, v130
    v_add_f32 v147, v147, v131
    v_add_f32 v148, v148, v132
    v_add_f32 v149, v149, v133
    v_add_f32 v150, v150, v134
    v_add_f32 v151, v151, v135
    v_add_f32 v144, v144, v136
    v_add_f32 v145, v145, v137
    v_add_f32 v146, v146, v138
    v_add_f32 v147, v147, v139
    v_add_f32 v148, v148, v140
    v_add_f32 v149, v149, v141
    v_add_f32 v150, v150, v142
    v_add_f32 v151, v151, v143
    v_add_f32 v144, v144, v176
    v_add_f32 v145, v145, v177
    v_add_f32 v146, v146, v178
    v_add_f32 v147, v147, v179
    v_add_f32 v148, v148, v180
    v_add_f32 v149, v149, v181
    v_add_f32 v150, v150, v182
    v_add_f32 v151, v151, v183
    v_add_f32 v144, v144, v184
    v_add_f32 v145, v145, v185
    v_add_f32 v146, v146, v186
    v_add_f32 v147, v147, v187
    v_add_f32 v148, v148, v188
    v_add_f32 v149, v149, v189
    v_add_f32 v150, v150, v190
    v_add_f32 v151, v151, v191
    s_cmp_eq_u32 s7, 0
    s_cbranch_scc1 Lly_kt_116
    v_mov_b32 v232, v234
    v_mov_b32 v233, v235
Lly_kt_116:
    s_cmp_ge_u32 s6, 2
    s_cbranch_scc1 Lly_kvv_115
    v_fma_f32 v144, -v232, v248, v144
    v_mul_f32 v144, v233, v144
    v_fma_f32 v145, -v232, v249, v145
    v_mul_f32 v145, v233, v145
    v_fma_f32 v146, -v232, v250, v146
    v_mul_f32 v146, v233, v146
    v_fma_f32 v147, -v232, v251, v147
    v_mul_f32 v147, v233, v147
    v_fma_f32 v148, -v232, v252, v148
    v_mul_f32 v148, v233, v148
    v_fma_f32 v149, -v232, v253, v149
    v_mul_f32 v149, v233, v149
    v_fma_f32 v150, -v232, v254, v150
    v_mul_f32 v150, v233, v150
    v_fma_f32 v151, -v232, v255, v151
    v_mul_f32 v151, v233, v151
    v_cvt_pk_bf16_f32 v160, v144, v145
    v_cvt_pk_bf16_f32 v161, v146, v147
    v_cvt_pk_bf16_f32 v162, v148, v149
    v_cvt_pk_bf16_f32 v163, v150, v151
    s_lshl_b32 s9, s8, 10
    s_add_u32 s9, s9, 16969728
    buffer_store_dwordx4 v[160:163], v3, s[40:43], s9 offen
    v_mov_b32 v8, 0
    v_dot2_f32_bf16 v8, v160, v160, v8
    v_dot2_f32_bf16 v8, v161, v161, v8
    v_dot2_f32_bf16 v8, v162, v162, v8
    v_dot2_f32_bf16 v8, v163, v163, v8
    s_nop 3
    v_mov_b32 v9, v8
    s_nop 1
    v_permlane32_swap_b32 v8, v9
    s_nop 1
    v_add_f32 v8, v8, v9
    s_nop 1
    v_max_f32_dpp v8, v8, v8 row_ror:8 row_mask:0xf bank_mask:0xf
    s_nop 1
    v_max_f32_dpp v8, v8, v8 row_ror:4 row_mask:0xf bank_mask:0xf
    s_nop 1
    v_max_f32_dpp v8, v8, v8 row_ror:2 row_mask:0xf bank_mask:0xf
    s_nop 1
    v_max_f32_dpp v8, v8, v8 row_ror:1 row_mask:0xf bank_mask:0xf
    s_nop 1
    v_mov_b32 v9, v8
    s_nop 1
    v_permlane16_swap_b32 v8, v9
    s_nop 1
    v_max_f32 v8, v8, v9
    s_lshl_b32 s9, s8, 2
    s_add_u32 s9, s9, 16965632
    v_mov_b32 v9, 0
    s_mov_b64 exec, 1
    buffer_store_dword v8, v9, s[40:43], s9 offen
    s_mov_b64 exec, -1
    s_branch Lly_kvfin_110
Lly_kvv_115:
    s_lshl_b32 s60, s3, 8
    v_and_b32 v4, 31, v1
    v_lshlrev_b32 v4, 2, v4
    v_add_u32 v4, s60, v4
    v_add_u32 v4, 159744, v4
    ds_write_b32 v4, v232
    ds_write_b32 v4, v233 offset:128
    v_lshrrev_b32 v5, 5, v1
    v_lshlrev_b32 v5, 4, v5
    s_lshl_b32 s61, s3, 6
    s_add_u32 s60, s60, s61
    v_add_u32 v5, s60, v5
    v_add_u32 v5, 159744, v5
    ds_read_b128 v[160:163], v5
    ds_read_b128 v[164:167], v5 offset:32
    ds_read_b128 v[168:171], v5 offset:128
    ds_read_b128 v[172:175], v5 offset:160
    s_waitcnt lgkmcnt(0)
    v_fma_f32 v144, -v160, v15, v144
    v_mul_f32 v144, v168, v144
    v_fma_f32 v145, -v161, v15, v145
    v_mul_f32 v145, v169, v145
    v_fma_f32 v146, -v162, v15, v146
    v_mul_f32 v146, v170, v146
    v_fma_f32 v147, -v163, v15, v147
    v_mul_f32 v147, v171, v147
    v_fma_f32 v148, -v164, v15, v148
    v_mul_f32 v148, v172, v148
    v_fma_f32 v149, -v165, v15, v149
    v_mul_f32 v149, v173, v149
    v_fma_f32 v150, -v166, v15, v150
    v_mul_f32 v150, v174, v150
    v_fma_f32 v151, -v167, v15, v151
    v_mul_f32 v151, v175, v151
    v_cvt_pk_bf16_f32 v176, v144, v145
    v_cvt_pk_bf16_f32 v177, v146, v147
    v_cvt_pk_bf16_f32 v178, v148, v149
    v_cvt_pk_bf16_f32 v179, v150, v151
    v_and_b32 v4, 15, v1
    v_lshrrev_b32 v5, 5, v1
    v_lshl_add_u32 v4, v5, 4, v4
    v_lshlrev_b32 v4, 4, v4
    s_lshl_b32 s9, s8, 1
    s_add_u32 s9, s9, s3
    s_mul_i32 s9, s9, 544
    s_add_u32 s9, s9, 17035264
    s_mov_b32 s12, 0xffff0000
    s_mov_b32 s13, 0xffff0000
    s_mov_b64 exec, s[12:13]
    buffer_store_dwordx4 v[176:179], v4, s[40:43], s9 offen
    s_mov_b64 exec, 3
    v_cmp_eq_u32 vcc, 0, v1
    v_mov_b32 v180, 0
    v_mov_b32 v181, s50
    s_nop 1
    v_cndmask_b32 v180, v180, v181, vcc
    v_mov_b32 v181, v180
    v_mov_b32 v182, v180
    v_mov_b32 v183, v180
    buffer_store_dwordx4 v[180:183], v3, s[40:43], s9 offen offset:512
    s_mov_b64 exec, -1
Lly_kvfin_110:
Lly_noq_81:
layer_body_exit:
    s_endpgm
.section .rodata,"a"
.p2align 6
.amdhsa_kernel pre_kernel
  .amdhsa_next_free_vgpr 256
  .amdhsa_next_free_sgpr 100
  .amdhsa_accum_offset 256
  .amdhsa_group_segment_fixed_size 0
  .amdhsa_kernarg_size 88
  .amdhsa_user_sgpr_count 2
  .amdhsa_user_sgpr_kernarg_segment_ptr 1
  .amdhsa_system_sgpr_workgroup_id_x 1
.end_amdhsa_kernel
.p2align 6
.amdhsa_kernel layer1_kernel
  .amdhsa_next_free_vgpr 256
  .amdhsa_next_free_sgpr 100
  .amdhsa_accum_offset 256
  .amdhsa_group_segment_fixed_size 0
  .amdhsa_kernarg_size 88
  .amdhsa_user_sgpr_count 2
  .amdhsa_user_sgpr_kernarg_segment_ptr 1
  .amdhsa_system_sgpr_workgroup_id_x 1
.end_amdhsa_kernel
.p2align 6
.amdhsa_kernel layer0_kernel
  .amdhsa_next_free_vgpr 256
  .amdhsa_next_free_sgpr 100
  .amdhsa_accum_offset 256
  .amdhsa_group_segment_fixed_size 0
  .amdhsa_kernarg_size 88
  .amdhsa_user_sgpr_count 2
  .amdhsa_user_sgpr_kernarg_segment_ptr 1
  .amdhsa_system_sgpr_workgroup_id_x 1
.end_amdhsa_kernel
```
